```python
import torch

def _softmax(x, axis=-1):
    return torch.softmax(x, dim=axis)
def _gelu(x):
    return torch.nn.functional.gelu(x, approximate="tanh")
def _silu(x):
    return torch.nn.functional.silu(x)
def _sigmoid(x):
    return torch.sigmoid(x)
def _layernorm(x, axis=-1, eps=1e-5):
    m = x.mean(dim=axis, keepdim=True)
    v = x.var(dim=axis, keepdim=True, unbiased=False)
    return (x - m) / torch.sqrt(v + eps)
def _scatter_add(tgt, idx, src, axis=0):
    return tgt.clone().index_add_(axis, idx, src)
def _segment_sum(src, seg, n):
    out = torch.zeros((n,) + src.shape[1:], dtype=src.dtype)
    return out.index_add_(0, seg, src)
def _pad(x, pw):
    flat = tuple(v for pair in reversed(pw) for v in pair)
    return torch.nn.functional.pad(x, flat)

kernel_name = 'concat_heads__sliding_block_cached__mha_block_cached__decode'

def setup_inputs():

    _w = (lambda a: (lambda t: t.to(torch.bfloat16) if t.is_floating_point() else t)(torch.as_tensor(a)))
    def _A_setup():
        B, Sq, D = 2, 1, 512
        Hq, Hkv, Sk, Dh = 32, 8, 16384, 128
        assert Hq % Hkv == 0, (Hq, Hkv)
        return {
            "x": _w((lambda *s: torch.randn(*s, dtype=torch.bfloat16) * 0.8)(B, Sq, D)),
            "k_cache": _w((lambda *s: torch.randn(*s, dtype=torch.bfloat16) * 1.6)(B, Hkv, Sk, Dh)),
            "v_cache": _w((lambda *s: torch.randn(*s, dtype=torch.bfloat16) * 0.2)(B, Hkv, Sk, Dh)),
            "wq": _w((lambda *s: torch.randn(*s, dtype=torch.bfloat16) * 1.6)(D, Hq * Dh) * (D ** -0.5)),
            "wo": _w((lambda *s: torch.randn(*s, dtype=torch.bfloat16) * 0.2)(Hq * Dh, D) * ((Hq * Dh) ** -0.5)),
        }
    _A_in = _A_setup()

    def _B_setup():
        B, Sq, D = 2, 1, 512
        H, Sk, Dh = 32, 16384, 128
        return {
            "x": _w((lambda *s: torch.randn(*s, dtype=torch.bfloat16) * 0.8)(B, Sq, D)),
            "k_cache": _w((lambda *s: torch.randn(*s, dtype=torch.bfloat16) * 1.6)(B, H, Sk, Dh)),
            "v_cache": _w((lambda *s: torch.randn(*s, dtype=torch.bfloat16) * 0.2)(B, H, Sk, Dh)),
            "wq": _w((lambda *s: torch.randn(*s, dtype=torch.bfloat16) * 1.6)(D, H * Dh) * (D ** -0.5)),
            "wo": _w((lambda *s: torch.randn(*s, dtype=torch.bfloat16) * 0.2)(H * Dh, D) * ((H * Dh) ** -0.5)),
        }
    _B_in = _B_setup()

    return {
        "A_x": _A_in["x"],
        "A_k_cache": _A_in["k_cache"],
        "A_v_cache": _A_in["v_cache"],
        "A_wq": _A_in["wq"],
        "A_wo": _A_in["wo"],
        "B_x": _B_in["x"],
        "B_k_cache": _B_in["k_cache"],
        "B_v_cache": _B_in["v_cache"],
        "B_wq": _B_in["wq"],
        "B_wo": _B_in["wo"],
    }

def reference(A_x, A_k_cache, A_v_cache, A_wq, A_wo, B_x, B_k_cache, B_v_cache, B_wq, B_wo):
    def _A_ref(x, k_cache, v_cache, wq, wo):
        B, Sq, D = x.shape
        Hq, Dh = 32, 128
        Hkv, Sk = k_cache.shape[1], k_cache.shape[2]
        W = min(4096, max(256, Sk // 4))
        rep = Hq // Hkv
        q = (lambda x, *d: x.permute(*d))((x @ wq).reshape(B, Sq, Hq, Dh), 0, 2, 1, 3)
        k = (lambda x, n, axis: torch.repeat_interleave(x, n, dim=axis))(k_cache[:, :, Sk - W:, :], rep, axis=1)
        v = (lambda x, n, axis: torch.repeat_interleave(x, n, dim=axis))(v_cache[:, :, Sk - W:, :], rep, axis=1)
        scores = torch.einsum("bhqd,bhkd->bhqk", q, k) * (Dh ** -0.5)
        p = _softmax(scores, axis=-1)
        o = torch.einsum("bhqk,bhkd->bhqd", p, v)
        return (lambda x, *d: x.permute(*d))(o, 0, 2, 1, 3).reshape(B, Sq, Hq * Dh) @ wo

    def _B_ref(x, k_cache, v_cache, wq, wo):
        B, Sq, D = x.shape
        H, Dh = 32, 128
        q = (lambda x, *d: x.permute(*d))((x @ wq).reshape(B, Sq, H, Dh), 0, 2, 1, 3)
        scores = torch.einsum("bhqd,bhkd->bhqk", q, k_cache) * (Dh ** -0.5)
        p = _softmax(scores, axis=-1)
        o = torch.einsum("bhqk,bhkd->bhqd", p, v_cache)
        return (lambda x, *d: x.permute(*d))(o, 0, 2, 1, 3).reshape(B, Sq, H * Dh) @ wo

    a = _A_ref(A_x, A_k_cache, A_v_cache, A_wq, A_wo)
    b = _B_ref(B_x, B_k_cache, B_v_cache, B_wq, B_wo)
    return torch.concatenate([a, b], axis=-1)
```

```asm
; @launch grid=(256,1,1) block=(256,1,1) lds=28672
.amdgcn_target "amdgcn-amd-amdhsa--gfx950"
.text
.globl concat_heads__sliding_block_cached__mha_block_cached__decode_kernel
.p2align 8
.type concat_heads__sliding_block_cached__mha_block_cached__decode_kernel,@function
concat_heads__sliding_block_cached__mha_block_cached__decode_kernel:
    s_cmp_ge_u32 s2, 256
    s_cbranch_scc1 L_end
    s_load_dwordx16 s[64:79], s[0:1], 0
    s_load_dwordx8 s[80:87], s[0:1], 64
    s_load_dwordx2 s[88:89], s[0:1], 96
    v_lshrrev_b32 v1, 6, v0
    s_nop 0
    v_readfirstlane_b32 s3, v1
    v_and_b32 v1, 63, v0
    v_and_b32 v2, 15, v1
    v_lshrrev_b32 v3, 4, v1
    v_bfe_u32 v58, v2, 2, 1
    v_lshlrev_b32 v58, 10, v58
    v_lshl_add_u32 v58, v3, 3, v58
    v_lshlrev_b32 v59, 15, v3
    v_lshl_add_u32 v59, v2, 4, v59
    v_lshlrev_b32 v4, 8, v2
    v_lshl_add_u32 v4, v3, 4, v4
    v_lshlrev_b32 v5, 10, v3
    v_lshl_add_u32 v5, v2, 4, v5
    s_and_b32 s50, s2, 3
    s_lshl_b32 s51, s50, 8
    s_lshl_b32 s52, s3, 6
    s_add_u32 s53, s51, s52
    s_lshl_b32 s51, s50, 20
    s_lshl_b32 s52, s3, 18
    s_add_u32 s51, s51, s52
    s_bfe_u32 s52, s2, 0x50002
    s_lshl_b32 s52, s52, 8
    s_add_u32 s51, s51, s52
    s_and_b32 s62, s2, 1
    s_lshl_b32 s62, s62, 7
    s_lshr_b32 s52, s2, 1
    s_or_b32 s62, s62, s52
    s_lshl_b32 s46, s2, 20
    s_lshl_b32 s52, s3, 12
    s_add_u32 s47, s46, s52
    s_waitcnt lgkmcnt(0)
    s_cmp_lt_u32 s2, 128
    s_cselect_b32 s28, s70, s80
    s_cselect_b32 s29, s71, s81
    s_mov_b32 s30, 0x400000
    s_mov_b32 s31, 0x20000
    s_cselect_b32 s32, s64, s74
    s_cselect_b32 s33, s65, s75
    s_mov_b32 s34, 0x800
    s_mov_b32 s35, 0x20000
    buffer_load_dwordx4 v[64:67], v59, s[28:31], s51 offen nt
    s_add_u32 s51, s51, 8192
    buffer_load_dwordx4 v[68:71], v59, s[28:31], s51 offen nt
    s_add_u32 s51, s51, 8192
    buffer_load_dwordx4 v[72:75], v59, s[28:31], s51 offen nt
    s_add_u32 s51, s51, 8192
    buffer_load_dwordx4 v[76:79], v59, s[28:31], s51 offen nt
    s_add_u32 s51, s51, 106496
    buffer_load_dwordx4 v[80:83], v59, s[28:31], s51 offen nt
    s_add_u32 s51, s51, 8192
    buffer_load_dwordx4 v[84:87], v59, s[28:31], s51 offen nt
    s_add_u32 s51, s51, 8192
    buffer_load_dwordx4 v[88:91], v59, s[28:31], s51 offen nt
    s_add_u32 s51, s51, 8192
    buffer_load_dwordx4 v[92:95], v59, s[28:31], s51 offen nt
    buffer_load_dwordx2 v[96:97], v58, s[32:35], s53 offen
    buffer_load_dwordx2 v[98:99], v58, s[32:35], s53 offen offset:32
    s_mov_b32 s24, s88
    s_mov_b32 s25, s89
    s_mov_b32 s26, 0x1000000
    s_mov_b32 s27, 0x20000
    buffer_load_dword v104, off, s[24:27], 0 sc0 sc1
    s_mov_b32 s16, s76
    s_mov_b32 s17, s77
    s_mov_b32 s18, 0x10000000
    s_mov_b32 s19, 0x20000
    s_mov_b32 s20, s78
    s_mov_b32 s21, s79
    s_mov_b32 s22, 0x10000000
    s_mov_b32 s23, 0x20000
    s_barrier
    buffer_load_dwordx4 a[0:3], v4, s[16:19], s47 offen offset:0 nt
    buffer_load_dwordx4 a[4:7], v4, s[16:19], s47 offen offset:64 nt
    buffer_load_dwordx4 a[8:11], v4, s[16:19], s47 offen offset:128 nt
    buffer_load_dwordx4 a[12:15], v4, s[16:19], s47 offen offset:192 nt
    buffer_load_dwordx4 a[16:19], v5, s[20:23], s47 offen offset:0 nt
    buffer_load_dwordx4 a[20:23], v5, s[20:23], s47 offen offset:256 nt
    buffer_load_dwordx4 a[24:27], v5, s[20:23], s47 offen offset:512 nt
    buffer_load_dwordx4 a[28:31], v5, s[20:23], s47 offen offset:768 nt
    s_mov_b32 s48, 0
    s_mov_b32 s8, s66
    s_mov_b32 s9, s67
    s_mov_b32 s10, 0x4000000
    s_mov_b32 s11, 0x20000
    s_mov_b32 s12, s68
    s_mov_b32 s13, s69
    s_mov_b32 s14, 0x4000000
    s_mov_b32 s15, 0x20000
    s_mov_b32 s40, s84
    s_mov_b32 s41, s85
    s_mov_b32 s42, 0x1000
    s_mov_b32 s43, 0x20000
    s_cmp_lt_u32 s62, 128
    s_cselect_b32 s36, s72, s82
    s_cselect_b32 s37, s73, s83
    s_mov_b32 s38, 0x400000
    s_mov_b32 s39, 0x20000
    v_and_b32 v63, 3, v2
    v_mov_b32 v6, 0x0c0c0c0c
    v_mov_b32 v58, 0x0c0c0100
    v_mov_b32 v59, 0x01000c0c
    v_cmp_eq_u32 vcc, 0, v63
    s_nop 1
    v_cndmask_b32 v6, v6, v58, vcc
    v_cmp_eq_u32 vcc, 1, v63
    s_nop 1
    v_cndmask_b32 v6, v6, v59, vcc
    v_mov_b32 v7, 0x0c0c0c0c
    v_mov_b32 v58, 0x0c0c0100
    v_mov_b32 v59, 0x01000c0c
    v_cmp_eq_u32 vcc, 2, v63
    s_nop 1
    v_cndmask_b32 v7, v7, v58, vcc
    v_cmp_eq_u32 vcc, 3, v63
    s_nop 1
    v_cndmask_b32 v7, v7, v59, vcc
    v_mov_b32 v8, 0x0c0c0c0c
    v_mov_b32 v58, 0x0c0c0302
    v_mov_b32 v59, 0x03020c0c
    v_cmp_eq_u32 vcc, 0, v63
    s_nop 1
    v_cndmask_b32 v8, v8, v58, vcc
    v_cmp_eq_u32 vcc, 1, v63
    s_nop 1
    v_cndmask_b32 v8, v8, v59, vcc
    v_mov_b32 v9, 0x0c0c0c0c
    v_mov_b32 v58, 0x0c0c0302
    v_mov_b32 v59, 0x03020c0c
    v_cmp_eq_u32 vcc, 2, v63
    s_nop 1
    v_cndmask_b32 v9, v9, v58, vcc
    v_cmp_eq_u32 vcc, 3, v63
    s_nop 1
    v_cndmask_b32 v9, v9, v59, vcc
    v_lshrrev_b32 v62, 2, v2
    v_lshlrev_b32 v62, 9, v62
    v_lshl_add_u32 v62, v3, 7, v62
    v_lshl_add_u32 v62, v63, 2, v62
    s_lshl_b32 s50, s3, 11
    v_add_u32 v62, s50, v62
    v_mov_b32 v13, 512
    v_mov_b32 v14, 1
    s_mov_b32 s45, 0x3fb8aa3b
    s_mov_b32 s101, 0x3db504f3
    s_lshr_b32 s51, s2, 4
    s_lshl_b32 s51, s51, 22
    s_add_u32 s51, s51, 0x300000
    s_and_b32 s52, s2, 15
    s_lshl_b32 s53, s52, 16
    s_add_u32 s7, s51, s53
    s_mul_i32 s5, s52, 0
    s_add_u32 s5, s5, 32
    s_mov_b32 s6, 0
    s_mov_b32 s61, 0
    s_mov_b32 s63, 0
    s_add_u32 s90, s5, 16
    s_mov_b32 s91, 0
    v_mov_b32 v10, 0xf149f2ca
    v_mov_b32 v11, 0xf149f2ca
    v_mov_b32 v12, 0
    v_mov_b32 v232, 0xf149f2ca
    v_mov_b32 v233, 0xf149f2ca
    v_mov_b32 v234, 0
    v_mov_b32 v224, 0
    v_mov_b32 v225, 0
    v_mov_b32 v226, 0
    v_mov_b32 v227, 0
    v_mov_b32 v228, 0
    v_mov_b32 v229, 0
    v_mov_b32 v230, 0
    v_mov_b32 v231, 0
    s_cmp_lg_u32 s3, 0
    s_cbranch_scc1 L_zc_1
    v_mov_b32 v58, 12
    v_mov_b32 v59, 0
    v_mov_b32 v60, 0
    v_mov_b32 v61, 0
    s_mov_b64 exec, 1
    ds_write_b128 v13, v[58:61]
    ds_write_b32 v13, v59 offset:16
    s_mov_b64 exec, -1
L_zc_1:
    v_mov_b32 v20, 0
    v_mov_b32 v21, 0
    v_mov_b32 v22, 0
    v_mov_b32 v23, 0
    v_mov_b32 v24, 0
    v_mov_b32 v25, 0
    v_mov_b32 v26, 0
    v_mov_b32 v27, 0
    s_waitcnt vmcnt(8)
    v_readfirstlane_b32 s44, v104
    v_perm_b32 v50, v96, v96, v6
    v_perm_b32 v51, v96, v96, v7
    v_perm_b32 v52, v96, v96, v8
    v_perm_b32 v53, v96, v96, v9
    v_perm_b32 v54, v97, v97, v6
    v_perm_b32 v55, v97, v97, v7
    v_perm_b32 v56, v97, v97, v8
    v_perm_b32 v57, v97, v97, v9
    s_add_u32 s44, s44, 0x9e3779b9
    s_nop 0
    v_mfma_f32_16x16x16_bf16 v[20:23], v[64:65], v[50:51], v[20:23]
    v_mfma_f32_16x16x16_bf16 v[24:27], v[66:67], v[50:51], v[24:27]
    v_mfma_f32_16x16x16_bf16 v[20:23], v[68:69], v[52:53], v[20:23]
    v_mfma_f32_16x16x16_bf16 v[24:27], v[70:71], v[52:53], v[24:27]
    v_mfma_f32_16x16x16_bf16 v[20:23], v[72:73], v[54:55], v[20:23]
    v_mfma_f32_16x16x16_bf16 v[24:27], v[74:75], v[54:55], v[24:27]
    v_mfma_f32_16x16x16_bf16 v[20:23], v[76:77], v[56:57], v[20:23]
    v_mfma_f32_16x16x16_bf16 v[24:27], v[78:79], v[56:57], v[24:27]
    s_nop 1
    v_perm_b32 v50, v98, v98, v6
    v_perm_b32 v51, v98, v98, v7
    v_perm_b32 v52, v98, v98, v8
    v_perm_b32 v53, v98, v98, v9
    v_perm_b32 v54, v99, v99, v6
    v_perm_b32 v55, v99, v99, v7
    v_perm_b32 v56, v99, v99, v8
    v_perm_b32 v57, v99, v99, v9
    s_nop 1
    v_mfma_f32_16x16x16_bf16 v[20:23], v[80:81], v[50:51], v[20:23]
    v_mfma_f32_16x16x16_bf16 v[24:27], v[82:83], v[50:51], v[24:27]
    v_mfma_f32_16x16x16_bf16 v[20:23], v[84:85], v[52:53], v[20:23]
    v_mfma_f32_16x16x16_bf16 v[24:27], v[86:87], v[52:53], v[24:27]
    v_mfma_f32_16x16x16_bf16 v[20:23], v[88:89], v[54:55], v[20:23]
    v_mfma_f32_16x16x16_bf16 v[24:27], v[90:91], v[54:55], v[24:27]
    v_mfma_f32_16x16x16_bf16 v[20:23], v[92:93], v[56:57], v[20:23]
    v_mfma_f32_16x16x16_bf16 v[24:27], v[94:95], v[56:57], v[24:27]
    s_nop 7
    s_nop 1
    ds_write_b32 v62, v20 offset:2304
    ds_write_b32 v62, v21 offset:2336
    ds_write_b32 v62, v22 offset:2368
    ds_write_b32 v62, v23 offset:2400
    ds_write_b32 v62, v24 offset:2320
    ds_write_b32 v62, v25 offset:2352
    ds_write_b32 v62, v26 offset:2384
    ds_write_b32 v62, v27 offset:2416
    s_waitcnt lgkmcnt(0)
    s_barrier
    v_lshlrev_b32 v58, 2, v0
    ds_read_b32 v64, v58 offset:2304
    ds_read_b32 v65, v58 offset:4352
    ds_read_b32 v66, v58 offset:6400
    ds_read_b32 v67, v58 offset:8448
    s_waitcnt lgkmcnt(0)
    v_add_f32 v64, v64, v65
    v_add_f32 v66, v66, v67
    v_add_f32 v64, v64, v66
    v_mov_b32 v65, s44
    v_lshlrev_b32 v58, 3, v0
    s_lshl_b32 s51, s2, 11
    s_add_u32 s51, s51, 4096
    buffer_store_dwordx2 v[64:65], v58, s[24:27], s51 offen sc0 sc1
    v_mov_b32 v20, 0
    v_mov_b32 v21, 0
    v_mov_b32 v22, 0
    v_mov_b32 v23, 0
    v_mov_b32 v24, 0
    v_mov_b32 v25, 0
    v_mov_b32 v26, 0
    v_mov_b32 v27, 0
    v_and_b32 v59, 127, v0
    v_lshlrev_b32 v59, 3, v59
    s_bfe_u32 s53, s2, 0x50002
    s_lshl_b32 s53, s53, 13
    s_lshr_b32 s54, s2, 7
    s_lshl_b32 s54, s54, 10
    s_add_u32 s53, s53, s54
    s_add_u32 s53, s53, 266240
    s_add_u32 s54, s53, 4096
    v_lshrrev_b32 v235, 7, v0
    v_lshlrev_b32 v235, 13, v235
    v_add_u32 v235, v235, v59
    s_bfe_u32 s51, s2, 0x30004
    s_lshl_b32 s51, s51, 15
    s_lshr_b32 s52, s2, 7
    s_lshl_b32 s52, s52, 10
    s_add_u32 s51, s51, s52
    s_add_u32 s92, s51, 4096
    s_add_u32 s93, s92, 4096
    s_add_u32 s94, s92, 16384
    s_add_u32 s95, s92, 20480
    s_cmp_ge_u32 s3, 2
    s_cselect_b32 s6, 1, 0
    s_add_u32 s47, s47, 16384
    s_mov_b32 s49, 0
    buffer_load_dwordx4 a[32:35], v4, s[16:19], s47 offen offset:0 nt
    buffer_load_dwordx4 a[36:39], v4, s[16:19], s47 offen offset:64 nt
    buffer_load_dwordx4 a[40:43], v4, s[16:19], s47 offen offset:128 nt
    buffer_load_dwordx4 a[44:47], v4, s[16:19], s47 offen offset:192 nt
    buffer_load_dwordx4 a[48:51], v5, s[20:23], s47 offen offset:0 nt
    buffer_load_dwordx4 a[52:55], v5, s[20:23], s47 offen offset:256 nt
    buffer_load_dwordx4 a[56:59], v5, s[20:23], s47 offen offset:512 nt
    buffer_load_dwordx4 a[60:63], v5, s[20:23], s47 offen offset:768 nt
    s_cmp_lg_u32 s6, 0
    s_cbranch_scc1 L_qi_2
    buffer_load_dwordx2 v[80:81], v59, s[24:27], s53 offen offset:0 sc0 sc1
    buffer_load_dwordx2 v[82:83], v59, s[24:27], s53 offen offset:2048 sc0 sc1
    buffer_load_dwordx2 v[84:85], v59, s[24:27], s54 offen offset:0 sc0 sc1
    buffer_load_dwordx2 v[86:87], v59, s[24:27], s54 offen offset:2048 sc0 sc1
L_qi_2:
    s_add_u32 s47, s47, 16384
    s_mov_b32 s4, 0
    buffer_load_dwordx4 a[64:67], v4, s[16:19], s47 offen offset:0 nt
    buffer_load_dwordx4 a[68:71], v4, s[16:19], s47 offen offset:64 nt
    buffer_load_dwordx4 a[72:75], v4, s[16:19], s47 offen offset:128 nt
    buffer_load_dwordx4 a[76:79], v4, s[16:19], s47 offen offset:192 nt
    buffer_load_dwordx4 a[80:83], v5, s[20:23], s47 offen offset:0 nt
    buffer_load_dwordx4 a[84:87], v5, s[20:23], s47 offen offset:256 nt
    buffer_load_dwordx4 a[88:91], v5, s[20:23], s47 offen offset:512 nt
    buffer_load_dwordx4 a[92:95], v5, s[20:23], s47 offen offset:768 nt
    s_cmp_lg_u32 s6, 0
    s_cbranch_scc1 L_qj_3
    s_waitcnt vmcnt(8)
    v_xor_b32 v63, s44, v81
    v_xor_b32 v83, s44, v83
    v_or_b32 v63, v63, v83
    v_xor_b32 v85, s44, v85
    v_or_b32 v63, v63, v85
    v_xor_b32 v87, s44, v87
    v_or_b32 v63, v63, v87
    v_cmp_ne_u32 vcc, 0, v63
    s_cbranch_vccnz L_qj_3
    s_mov_b32 s6, 2
L_qj_3:
    s_cmp_eq_u32 s6, 1
    s_cbranch_scc1 L_qw2_5
    s_cmp_eq_u32 s6, 2
    s_cbranch_scc1 L_qfo_4
    s_mov_b32 s56, 0
L_qb_6:
    buffer_load_dwordx2 v[80:81], v59, s[24:27], s53 offen offset:0 sc0 sc1
    buffer_load_dwordx2 v[82:83], v59, s[24:27], s53 offen offset:2048 sc0 sc1
    buffer_load_dwordx2 v[84:85], v59, s[24:27], s54 offen offset:0 sc0 sc1
    buffer_load_dwordx2 v[86:87], v59, s[24:27], s54 offen offset:2048 sc0 sc1
    s_waitcnt vmcnt(0)
L_qbchk_8:
    v_xor_b32 v63, s44, v81
    v_xor_b32 v83, s44, v83
    v_or_b32 v63, v63, v83
    v_xor_b32 v85, s44, v85
    v_or_b32 v63, v63, v85
    v_xor_b32 v87, s44, v87
    v_or_b32 v63, v63, v87
    v_cmp_ne_u32 vcc, 0, v63
    s_cbranch_vccz L_qbok_7
    s_add_u32 s56, s56, 1
    s_cmp_lt_u32 s56, 0x40000
    s_cbranch_scc0 L_qbok_7
    s_sleep 2
    s_branch L_qb_6
L_qbok_7:
L_qfo_4:
    v_add_f32 v80, v80, v82
    v_add_f32 v84, v84, v86
    v_add_f32 v80, v80, v84
    v_cvt_pk_bf16_f32 v80, v80, v80
    v_lshlrev_b32 v60, 1, v0
    ds_write_b16 v60, v80 offset:1920
L_qw2_5:
    s_mov_b32 s6, 0
    s_waitcnt lgkmcnt(0)
    s_barrier
    v_lshlrev_b32 v58, 4, v3
    ds_read_b128 v[28:31], v58 offset:1920
    ds_read_b128 v[32:35], v58 offset:1984
    ds_read_b128 v[36:39], v58 offset:2048
    ds_read_b128 v[40:43], v58 offset:2112
    s_waitcnt lgkmcnt(0)
L_loop:
    s_cmp_lt_u32 s61, 2
    s_cbranch_scc1 L_qa
    s_cmp_ge_u32 s91, s90
    s_cbranch_scc1 L_afl
L_loop_c:
    s_cmp_ge_u32 s48, 0x8000
    s_cbranch_scc1 L_done
    s_bitcmp1_b32 s48, 12
    s_cbranch_scc1 L_cA_9
    s_mov_b64 exec, 1
    ds_add_rtn_u32 v15, v13, v14
    s_mov_b64 exec, -1
    s_waitcnt vmcnt(20)
    v_mfma_f32_16x16x32_bf16 v[16:19], a[0:3], v[28:31], 0
    v_mfma_f32_16x16x32_bf16 v[16:19], a[4:7], v[32:35], v[16:19]
    v_mfma_f32_16x16x32_bf16 v[16:19], a[8:11], v[36:39], v[16:19]
    v_mfma_f32_16x16x32_bf16 v[16:19], a[12:15], v[40:43], v[16:19]
    s_waitcnt lgkmcnt(0)
    v_readfirstlane_b32 s48, v15
    s_nop 3
    s_mov_b32 s91, s48
    s_sub_u32 s50, s48, s5
    s_cmp_lt_u32 s50, 16
    s_cbranch_scc1 L_refA_11
    s_cmp_ge_u32 s48, 272
    s_cbranch_scc1 L_refI_12
    s_cmp_ge_u32 s48, s5
    s_cselect_b32 s50, 16, 0
    s_sub_u32 s50, s48, s50
    s_lshl_b32 s50, s50, 12
    s_add_u32 s47, s46, s50
L_normK_14:
    buffer_load_dwordx4 a[0:3], v4, s[16:19], s47 offen offset:0 nt
    buffer_load_dwordx4 a[4:7], v4, s[16:19], s47 offen offset:64 nt
    buffer_load_dwordx4 a[8:11], v4, s[16:19], s47 offen offset:128 nt
    buffer_load_dwordx4 a[12:15], v4, s[16:19], s47 offen offset:192 nt
L_afterK_13:
    v_cvt_pk_bf16_f32 v58, v16, v17
    v_cvt_pk_bf16_f32 v59, v18, v19
    v_lshlrev_b32 v16, 16, v58
    v_and_b32 v17, 0xffff0000, v58
    v_lshlrev_b32 v18, 16, v59
    v_and_b32 v19, 0xffff0000, v59
    v_mul_f32 v16, s101, v16
    v_mul_f32 v17, s101, v17
    v_mul_f32 v18, s101, v18
    v_mul_f32 v19, s101, v19
    v_cvt_pk_bf16_f32 v58, v16, v17
    v_cvt_pk_bf16_f32 v59, v18, v19
    v_lshlrev_b32 v16, 16, v58
    v_and_b32 v17, 0xffff0000, v58
    v_lshlrev_b32 v18, 16, v59
    v_and_b32 v19, 0xffff0000, v59
    v_max3_f32 v58, v16, v17, v18
    v_max_f32 v58, v58, v19
    v_cmp_gt_f32 vcc, v58, v10
    s_cbranch_vccz L_fast_17
    v_mov_b32 v59, v58
    s_nop 1
    v_permlane32_swap_b32 v59, v58
    s_nop 1
    v_max_f32 v58, v58, v59
    v_mov_b32 v59, v58
    s_nop 1
    v_permlane16_swap_b32 v59, v58
    s_nop 1
    v_max_f32 v58, v58, v59
    v_max_f32 v10, v10, v58
    v_mul_f32 v59, s45, v10
    v_sub_f32 v60, v11, v59
    v_exp_f32 v60, v60
    v_mov_b32 v11, v59
    v_mul_f32 v12, v12, v60
    v_mul_f32 v20, v20, v60
    v_mul_f32 v21, v21, v60
    v_mul_f32 v22, v22, v60
    v_mul_f32 v23, v23, v60
    v_mul_f32 v24, v24, v60
    v_mul_f32 v25, v25, v60
    v_mul_f32 v26, v26, v60
    v_mul_f32 v27, v27, v60
L_fast_17:
    v_fma_f32 v44, v16, s45, -v11
    v_fma_f32 v45, v17, s45, -v11
    v_fma_f32 v46, v18, s45, -v11
    v_fma_f32 v47, v19, s45, -v11
    v_exp_f32 v44, v44
    v_exp_f32 v45, v45
    v_exp_f32 v46, v46
    v_exp_f32 v47, v47
    s_nop 0
    v_cvt_pk_bf16_f32 v48, v44, v45
    v_cvt_pk_bf16_f32 v49, v46, v47
    v_add_f32 v44, v44, v45
    v_add_f32 v46, v46, v47
    v_perm_b32 v50, v48, v48, v6
    v_perm_b32 v51, v48, v48, v7
    v_perm_b32 v52, v48, v48, v8
    v_perm_b32 v53, v48, v48, v9
    v_perm_b32 v54, v49, v49, v6
    v_perm_b32 v55, v49, v49, v7
    v_perm_b32 v56, v49, v49, v8
    v_perm_b32 v57, v49, v49, v9
    v_add_f32 v12, v12, v44
    v_add_f32 v12, v12, v46
    s_waitcnt vmcnt(20)
    v_mfma_f32_16x16x16_bf16 v[20:23], a[16:17], v[50:51], v[20:23]
    v_mfma_f32_16x16x16_bf16 v[24:27], a[18:19], v[50:51], v[24:27]
    v_mfma_f32_16x16x16_bf16 v[20:23], a[20:21], v[52:53], v[20:23]
    v_mfma_f32_16x16x16_bf16 v[24:27], a[22:23], v[52:53], v[24:27]
    v_mfma_f32_16x16x16_bf16 v[20:23], a[24:25], v[54:55], v[20:23]
    v_mfma_f32_16x16x16_bf16 v[24:27], a[26:27], v[54:55], v[24:27]
    v_mfma_f32_16x16x16_bf16 v[20:23], a[28:29], v[56:57], v[20:23]
    v_mfma_f32_16x16x16_bf16 v[24:27], a[30:31], v[56:57], v[24:27]
    s_cmp_ge_u32 s48, 0x1000
    s_cbranch_scc1 L_vx_15
L_afterV_16_n:
    buffer_load_dwordx4 a[16:19], v5, s[20:23], s47 offen offset:0 nt
    buffer_load_dwordx4 a[20:23], v5, s[20:23], s47 offen offset:256 nt
    buffer_load_dwordx4 a[24:27], v5, s[20:23], s47 offen offset:512 nt
    buffer_load_dwordx4 a[28:31], v5, s[20:23], s47 offen offset:768 nt
L_afterV_16:
L_cR_10:
    s_cmp_ge_u32 s49, 0x8000
    s_cbranch_scc1 L_done
    s_bitcmp1_b32 s49, 12
    s_cbranch_scc1 L_cA_18
    s_mov_b64 exec, 1
    ds_add_rtn_u32 v15, v13, v14
    s_mov_b64 exec, -1
    s_waitcnt vmcnt(20)
    v_mfma_f32_16x16x32_bf16 v[16:19], a[32:35], v[28:31], 0
    v_mfma_f32_16x16x32_bf16 v[16:19], a[36:39], v[32:35], v[16:19]
    v_mfma_f32_16x16x32_bf16 v[16:19], a[40:43], v[36:39], v[16:19]
    v_mfma_f32_16x16x32_bf16 v[16:19], a[44:47], v[40:43], v[16:19]
    s_waitcnt lgkmcnt(0)
    v_readfirstlane_b32 s49, v15
    s_nop 3
    s_mov_b32 s91, s49
    s_sub_u32 s50, s49, s5
    s_cmp_lt_u32 s50, 16
    s_cbranch_scc1 L_refA_20
    s_cmp_ge_u32 s49, 272
    s_cbranch_scc1 L_refI_21
    s_cmp_ge_u32 s49, s5
    s_cselect_b32 s50, 16, 0
    s_sub_u32 s50, s49, s50
    s_lshl_b32 s50, s50, 12
    s_add_u32 s47, s46, s50
L_normK_23:
    buffer_load_dwordx4 a[32:35], v4, s[16:19], s47 offen offset:0 nt
    buffer_load_dwordx4 a[36:39], v4, s[16:19], s47 offen offset:64 nt
    buffer_load_dwordx4 a[40:43], v4, s[16:19], s47 offen offset:128 nt
    buffer_load_dwordx4 a[44:47], v4, s[16:19], s47 offen offset:192 nt
L_afterK_22:
    v_cvt_pk_bf16_f32 v58, v16, v17
    v_cvt_pk_bf16_f32 v59, v18, v19
    v_lshlrev_b32 v16, 16, v58
    v_and_b32 v17, 0xffff0000, v58
    v_lshlrev_b32 v18, 16, v59
    v_and_b32 v19, 0xffff0000, v59
    v_mul_f32 v16, s101, v16
    v_mul_f32 v17, s101, v17
    v_mul_f32 v18, s101, v18
    v_mul_f32 v19, s101, v19
    v_cvt_pk_bf16_f32 v58, v16, v17
    v_cvt_pk_bf16_f32 v59, v18, v19
    v_lshlrev_b32 v16, 16, v58
    v_and_b32 v17, 0xffff0000, v58
    v_lshlrev_b32 v18, 16, v59
    v_and_b32 v19, 0xffff0000, v59
    v_max3_f32 v58, v16, v17, v18
    v_max_f32 v58, v58, v19
    v_cmp_gt_f32 vcc, v58, v10
    s_cbranch_vccz L_fast_26
    v_mov_b32 v59, v58
    s_nop 1
    v_permlane32_swap_b32 v59, v58
    s_nop 1
    v_max_f32 v58, v58, v59
    v_mov_b32 v59, v58
    s_nop 1
    v_permlane16_swap_b32 v59, v58
    s_nop 1
    v_max_f32 v58, v58, v59
    v_max_f32 v10, v10, v58
    v_mul_f32 v59, s45, v10
    v_sub_f32 v60, v11, v59
    v_exp_f32 v60, v60
    v_mov_b32 v11, v59
    v_mul_f32 v12, v12, v60
    v_mul_f32 v20, v20, v60
    v_mul_f32 v21, v21, v60
    v_mul_f32 v22, v22, v60
    v_mul_f32 v23, v23, v60
    v_mul_f32 v24, v24, v60
    v_mul_f32 v25, v25, v60
    v_mul_f32 v26, v26, v60
    v_mul_f32 v27, v27, v60
L_fast_26:
    v_fma_f32 v44, v16, s45, -v11
    v_fma_f32 v45, v17, s45, -v11
    v_fma_f32 v46, v18, s45, -v11
    v_fma_f32 v47, v19, s45, -v11
    v_exp_f32 v44, v44
    v_exp_f32 v45, v45
    v_exp_f32 v46, v46
    v_exp_f32 v47, v47
    s_nop 0
    v_cvt_pk_bf16_f32 v48, v44, v45
    v_cvt_pk_bf16_f32 v49, v46, v47
    v_add_f32 v44, v44, v45
    v_add_f32 v46, v46, v47
    v_perm_b32 v50, v48, v48, v6
    v_perm_b32 v51, v48, v48, v7
    v_perm_b32 v52, v48, v48, v8
    v_perm_b32 v53, v48, v48, v9
    v_perm_b32 v54, v49, v49, v6
    v_perm_b32 v55, v49, v49, v7
    v_perm_b32 v56, v49, v49, v8
    v_perm_b32 v57, v49, v49, v9
    v_add_f32 v12, v12, v44
    v_add_f32 v12, v12, v46
    s_waitcnt vmcnt(20)
    v_mfma_f32_16x16x16_bf16 v[20:23], a[48:49], v[50:51], v[20:23]
    v_mfma_f32_16x16x16_bf16 v[24:27], a[50:51], v[50:51], v[24:27]
    v_mfma_f32_16x16x16_bf16 v[20:23], a[52:53], v[52:53], v[20:23]
    v_mfma_f32_16x16x16_bf16 v[24:27], a[54:55], v[52:53], v[24:27]
    v_mfma_f32_16x16x16_bf16 v[20:23], a[56:57], v[54:55], v[20:23]
    v_mfma_f32_16x16x16_bf16 v[24:27], a[58:59], v[54:55], v[24:27]
    v_mfma_f32_16x16x16_bf16 v[20:23], a[60:61], v[56:57], v[20:23]
    v_mfma_f32_16x16x16_bf16 v[24:27], a[62:63], v[56:57], v[24:27]
    s_cmp_ge_u32 s49, 0x1000
    s_cbranch_scc1 L_vx_24
L_afterV_25_n:
    buffer_load_dwordx4 a[48:51], v5, s[20:23], s47 offen offset:0 nt
    buffer_load_dwordx4 a[52:55], v5, s[20:23], s47 offen offset:256 nt
    buffer_load_dwordx4 a[56:59], v5, s[20:23], s47 offen offset:512 nt
    buffer_load_dwordx4 a[60:63], v5, s[20:23], s47 offen offset:768 nt
L_afterV_25:
L_cR_19:
    s_cmp_ge_u32 s4, 0x8000
    s_cbranch_scc1 L_done
    s_bitcmp1_b32 s4, 12
    s_cbranch_scc1 L_cA_27
    s_mov_b64 exec, 1
    ds_add_rtn_u32 v15, v13, v14
    s_mov_b64 exec, -1
    s_waitcnt vmcnt(20)
    v_mfma_f32_16x16x32_bf16 v[16:19], a[64:67], v[28:31], 0
    v_mfma_f32_16x16x32_bf16 v[16:19], a[68:71], v[32:35], v[16:19]
    v_mfma_f32_16x16x32_bf16 v[16:19], a[72:75], v[36:39], v[16:19]
    v_mfma_f32_16x16x32_bf16 v[16:19], a[76:79], v[40:43], v[16:19]
    s_waitcnt lgkmcnt(0)
    v_readfirstlane_b32 s4, v15
    s_nop 3
    s_mov_b32 s91, s4
    s_sub_u32 s50, s4, s5
    s_cmp_lt_u32 s50, 16
    s_cbranch_scc1 L_refA_29
    s_cmp_ge_u32 s4, 272
    s_cbranch_scc1 L_refI_30
    s_cmp_ge_u32 s4, s5
    s_cselect_b32 s50, 16, 0
    s_sub_u32 s50, s4, s50
    s_lshl_b32 s50, s50, 12
    s_add_u32 s47, s46, s50
L_normK_32:
    buffer_load_dwordx4 a[64:67], v4, s[16:19], s47 offen offset:0 nt
    buffer_load_dwordx4 a[68:71], v4, s[16:19], s47 offen offset:64 nt
    buffer_load_dwordx4 a[72:75], v4, s[16:19], s47 offen offset:128 nt
    buffer_load_dwordx4 a[76:79], v4, s[16:19], s47 offen offset:192 nt
L_afterK_31:
    v_cvt_pk_bf16_f32 v58, v16, v17
    v_cvt_pk_bf16_f32 v59, v18, v19
    v_lshlrev_b32 v16, 16, v58
    v_and_b32 v17, 0xffff0000, v58
    v_lshlrev_b32 v18, 16, v59
    v_and_b32 v19, 0xffff0000, v59
    v_mul_f32 v16, s101, v16
    v_mul_f32 v17, s101, v17
    v_mul_f32 v18, s101, v18
    v_mul_f32 v19, s101, v19
    v_cvt_pk_bf16_f32 v58, v16, v17
    v_cvt_pk_bf16_f32 v59, v18, v19
    v_lshlrev_b32 v16, 16, v58
    v_and_b32 v17, 0xffff0000, v58
    v_lshlrev_b32 v18, 16, v59
    v_and_b32 v19, 0xffff0000, v59
    v_max3_f32 v58, v16, v17, v18
    v_max_f32 v58, v58, v19
    v_cmp_gt_f32 vcc, v58, v10
    s_cbranch_vccz L_fast_35
    v_mov_b32 v59, v58
    s_nop 1
    v_permlane32_swap_b32 v59, v58
    s_nop 1
    v_max_f32 v58, v58, v59
    v_mov_b32 v59, v58
    s_nop 1
    v_permlane16_swap_b32 v59, v58
    s_nop 1
    v_max_f32 v58, v58, v59
    v_max_f32 v10, v10, v58
    v_mul_f32 v59, s45, v10
    v_sub_f32 v60, v11, v59
    v_exp_f32 v60, v60
    v_mov_b32 v11, v59
    v_mul_f32 v12, v12, v60
    v_mul_f32 v20, v20, v60
    v_mul_f32 v21, v21, v60
    v_mul_f32 v22, v22, v60
    v_mul_f32 v23, v23, v60
    v_mul_f32 v24, v24, v60
    v_mul_f32 v25, v25, v60
    v_mul_f32 v26, v26, v60
    v_mul_f32 v27, v27, v60
L_fast_35:
    v_fma_f32 v44, v16, s45, -v11
    v_fma_f32 v45, v17, s45, -v11
    v_fma_f32 v46, v18, s45, -v11
    v_fma_f32 v47, v19, s45, -v11
    v_exp_f32 v44, v44
    v_exp_f32 v45, v45
    v_exp_f32 v46, v46
    v_exp_f32 v47, v47
    s_nop 0
    v_cvt_pk_bf16_f32 v48, v44, v45
    v_cvt_pk_bf16_f32 v49, v46, v47
    v_add_f32 v44, v44, v45
    v_add_f32 v46, v46, v47
    v_perm_b32 v50, v48, v48, v6
    v_perm_b32 v51, v48, v48, v7
    v_perm_b32 v52, v48, v48, v8
    v_perm_b32 v53, v48, v48, v9
    v_perm_b32 v54, v49, v49, v6
    v_perm_b32 v55, v49, v49, v7
    v_perm_b32 v56, v49, v49, v8
    v_perm_b32 v57, v49, v49, v9
    v_add_f32 v12, v12, v44
    v_add_f32 v12, v12, v46
    s_waitcnt vmcnt(20)
    v_mfma_f32_16x16x16_bf16 v[20:23], a[80:81], v[50:51], v[20:23]
    v_mfma_f32_16x16x16_bf16 v[24:27], a[82:83], v[50:51], v[24:27]
    v_mfma_f32_16x16x16_bf16 v[20:23], a[84:85], v[52:53], v[20:23]
    v_mfma_f32_16x16x16_bf16 v[24:27], a[86:87], v[52:53], v[24:27]
    v_mfma_f32_16x16x16_bf16 v[20:23], a[88:89], v[54:55], v[20:23]
    v_mfma_f32_16x16x16_bf16 v[24:27], a[90:91], v[54:55], v[24:27]
    v_mfma_f32_16x16x16_bf16 v[20:23], a[92:93], v[56:57], v[20:23]
    v_mfma_f32_16x16x16_bf16 v[24:27], a[94:95], v[56:57], v[24:27]
    s_cmp_ge_u32 s4, 0x1000
    s_cbranch_scc1 L_vx_33
L_afterV_34_n:
    buffer_load_dwordx4 a[80:83], v5, s[20:23], s47 offen offset:0 nt
    buffer_load_dwordx4 a[84:87], v5, s[20:23], s47 offen offset:256 nt
    buffer_load_dwordx4 a[88:91], v5, s[20:23], s47 offen offset:512 nt
    buffer_load_dwordx4 a[92:95], v5, s[20:23], s47 offen offset:768 nt
L_afterV_34:
L_cR_28:
    s_branch L_loop
L_afl:
    s_or_b32 s50, s48, s49
    s_or_b32 s50, s50, s4
    s_bitcmp1_b32 s50, 12
    s_cbranch_scc1 L_loop_c
    s_mov_b32 s90, -1
    v_mov_b32 v59, v234
    s_nop 1
    v_permlane32_swap_b32 v59, v234
    s_nop 1
    v_add_f32 v234, v234, v59
    v_mov_b32 v59, v234
    s_nop 1
    v_permlane16_swap_b32 v59, v234
    s_nop 1
    v_add_f32 v234, v234, v59
    s_nop 7
    ds_write_b32 v62, v224 offset:10496
    ds_write_b32 v62, v225 offset:10528
    ds_write_b32 v62, v226 offset:10560
    ds_write_b32 v62, v227 offset:10592
    ds_write_b32 v62, v228 offset:10512
    ds_write_b32 v62, v229 offset:10544
    ds_write_b32 v62, v230 offset:10576
    ds_write_b32 v62, v231 offset:10608
    v_lshrrev_b32 v58, 2, v2
    v_lshlrev_b32 v58, 3, v58
    s_lshl_b32 s50, s3, 5
    v_add_u32 v58, s50, v58
    v_mov_b32 v60, v233
    v_mov_b32 v61, v234
    ds_write_b64 v58, v[60:61] offset:0
    s_waitcnt lgkmcnt(0)
    s_mov_b64 exec, 1
    ds_add_rtn_u32 v58, v13, v14 offset:4
    s_mov_b64 exec, -1
    s_waitcnt lgkmcnt(0)
    v_readfirstlane_b32 s50, v58
    s_nop 3
    s_cmp_lg_u32 s50, 3
    s_cbranch_scc1 L_nomerge_36
    v_and_b32 v58, 3, v1
    v_lshlrev_b32 v58, 3, v58
    ds_read_b64 v[96:97], v58 offset:0
    ds_read_b64 v[98:99], v58 offset:32
    ds_read_b64 v[100:101], v58 offset:64
    ds_read_b64 v[102:103], v58 offset:96
    v_lshlrev_b32 v59, 3, v1
    ds_read_b64 v[108:109], v59 offset:10496
    ds_read_b64 v[110:111], v59 offset:12544
    ds_read_b64 v[112:113], v59 offset:14592
    ds_read_b64 v[114:115], v59 offset:16640
    ds_read_b64 v[116:117], v59 offset:11008
    ds_read_b64 v[118:119], v59 offset:13056
    ds_read_b64 v[120:121], v59 offset:15104
    ds_read_b64 v[122:123], v59 offset:17152
    ds_read_b64 v[124:125], v59 offset:11520
    ds_read_b64 v[126:127], v59 offset:13568
    ds_read_b64 v[128:129], v59 offset:15616
    ds_read_b64 v[130:131], v59 offset:17664
    ds_read_b64 v[132:133], v59 offset:12032
    ds_read_b64 v[134:135], v59 offset:14080
    ds_read_b64 v[136:137], v59 offset:16128
    ds_read_b64 v[138:139], v59 offset:18176
    s_waitcnt lgkmcnt(15)
    s_waitcnt lgkmcnt(12)
    v_max3_f32 v104, v96, v98, v100
    v_max_f32 v104, v104, v102
    v_sub_f32 v96, v96, v104
    v_sub_f32 v98, v98, v104
    v_sub_f32 v100, v100, v104
    v_sub_f32 v102, v102, v104
    v_exp_f32 v96, v96
    v_exp_f32 v98, v98
    v_exp_f32 v100, v100
    v_exp_f32 v102, v102
    s_nop 0
    v_mul_f32 v106, v96, v97
    v_fmac_f32 v106, v98, v99
    v_fmac_f32 v106, v100, v101
    v_fmac_f32 v106, v102, v103
    v_mov_b32 v105, s44
    v_mov_b32 v107, s44
    v_readlane_b32 s64, v96, 0
    v_readlane_b32 s65, v98, 0
    v_readlane_b32 s66, v100, 0
    v_readlane_b32 s67, v102, 0
    v_readlane_b32 s68, v96, 1
    v_readlane_b32 s69, v98, 1
    v_readlane_b32 s70, v100, 1
    v_readlane_b32 s71, v102, 1
    v_readlane_b32 s72, v96, 2
    v_readlane_b32 s73, v98, 2
    v_readlane_b32 s74, v100, 2
    v_readlane_b32 s75, v102, 2
    v_readlane_b32 s76, v96, 3
    v_readlane_b32 s77, v98, 3
    v_readlane_b32 s78, v100, 3
    v_readlane_b32 s79, v102, 3
    s_waitcnt lgkmcnt(0)
    v_mul_f32 v140, s64, v108
    v_mul_f32 v142, s64, v109
    v_fmac_f32 v140, s65, v110
    v_fmac_f32 v142, s65, v111
    v_fmac_f32 v140, s66, v112
    v_fmac_f32 v142, s66, v113
    v_fmac_f32 v140, s67, v114
    v_fmac_f32 v142, s67, v115
    v_mov_b32 v141, s44
    v_mov_b32 v143, s44
    v_mul_f32 v144, s68, v116
    v_mul_f32 v146, s68, v117
    v_fmac_f32 v144, s69, v118
    v_fmac_f32 v146, s69, v119
    v_fmac_f32 v144, s70, v120
    v_fmac_f32 v146, s70, v121
    v_fmac_f32 v144, s71, v122
    v_fmac_f32 v146, s71, v123
    v_mov_b32 v145, s44
    v_mov_b32 v147, s44
    v_mul_f32 v148, s72, v124
    v_mul_f32 v150, s72, v125
    v_fmac_f32 v148, s73, v126
    v_fmac_f32 v150, s73, v127
    v_fmac_f32 v148, s74, v128
    v_fmac_f32 v150, s74, v129
    v_fmac_f32 v148, s75, v130
    v_fmac_f32 v150, s75, v131
    v_mov_b32 v149, s44
    v_mov_b32 v151, s44
    v_mul_f32 v152, s76, v132
    v_mul_f32 v154, s76, v133
    v_fmac_f32 v152, s77, v134
    v_fmac_f32 v154, s77, v135
    v_fmac_f32 v152, s78, v136
    v_fmac_f32 v154, s78, v137
    v_fmac_f32 v152, s79, v138
    v_fmac_f32 v154, s79, v139
    v_mov_b32 v153, s44
    v_mov_b32 v155, s44
    s_mul_i32 s50, s2, 4352
    s_add_u32 s50, s50, 1048576
    v_lshlrev_b32 v59, 4, v1
    buffer_store_dwordx4 v[140:143], v59, s[24:27], s50 offen offset:0 sc0 sc1
    buffer_store_dwordx4 v[144:147], v59, s[24:27], s50 offen offset:1024 sc0 sc1
    buffer_store_dwordx4 v[148:151], v59, s[24:27], s50 offen offset:2048 sc0 sc1
    buffer_store_dwordx4 v[152:155], v59, s[24:27], s50 offen offset:3072 sc0 sc1
    s_add_u32 s50, s50, 4096
    s_mov_b64 exec, 15
    buffer_store_dwordx4 v[104:107], v59, s[24:27], s50 offen sc0 sc1
    s_mov_b64 exec, -1
L_nomerge_36:
    s_branch L_loop_c
L_qa:
    s_cmp_lg_u32 s61, 0
    s_cbranch_scc1 L_qa2
    s_mov_b32 s61, 1
    buffer_load_dwordx2 v[64:65], v235, s[24:27], s92 offen offset:0 sc0 sc1
    buffer_load_dwordx2 v[66:67], v235, s[24:27], s92 offen offset:2048 sc0 sc1
    buffer_load_dwordx2 v[68:69], v235, s[24:27], s93 offen offset:0 sc0 sc1
    buffer_load_dwordx2 v[70:71], v235, s[24:27], s93 offen offset:2048 sc0 sc1
    buffer_load_dwordx2 v[72:73], v235, s[24:27], s94 offen offset:0 sc0 sc1
    buffer_load_dwordx2 v[74:75], v235, s[24:27], s94 offen offset:2048 sc0 sc1
    buffer_load_dwordx2 v[76:77], v235, s[24:27], s95 offen offset:0 sc0 sc1
    buffer_load_dwordx2 v[78:79], v235, s[24:27], s95 offen offset:2048 sc0 sc1
    s_branch L_loop_c
L_qa2:
    s_mov_b32 s61, 2
    s_mov_b32 s56, 0
    s_waitcnt vmcnt(24)
    s_branch L_qachk_39
L_qa_37:
    buffer_load_dwordx2 v[64:65], v235, s[24:27], s92 offen offset:0 sc0 sc1
    buffer_load_dwordx2 v[66:67], v235, s[24:27], s92 offen offset:2048 sc0 sc1
    buffer_load_dwordx2 v[68:69], v235, s[24:27], s93 offen offset:0 sc0 sc1
    buffer_load_dwordx2 v[70:71], v235, s[24:27], s93 offen offset:2048 sc0 sc1
    buffer_load_dwordx2 v[72:73], v235, s[24:27], s94 offen offset:0 sc0 sc1
    buffer_load_dwordx2 v[74:75], v235, s[24:27], s94 offen offset:2048 sc0 sc1
    buffer_load_dwordx2 v[76:77], v235, s[24:27], s95 offen offset:0 sc0 sc1
    buffer_load_dwordx2 v[78:79], v235, s[24:27], s95 offen offset:2048 sc0 sc1
    s_waitcnt vmcnt(0)
L_qachk_39:
    v_xor_b32 v63, s44, v65
    v_xor_b32 v67, s44, v67
    v_or_b32 v63, v63, v67
    v_xor_b32 v69, s44, v69
    v_or_b32 v63, v63, v69
    v_xor_b32 v71, s44, v71
    v_or_b32 v63, v63, v71
    v_xor_b32 v73, s44, v73
    v_or_b32 v63, v63, v73
    v_xor_b32 v75, s44, v75
    v_or_b32 v63, v63, v75
    v_xor_b32 v77, s44, v77
    v_or_b32 v63, v63, v77
    v_xor_b32 v79, s44, v79
    v_or_b32 v63, v63, v79
    v_cmp_ne_u32 vcc, 0, v63
    s_cbranch_vccz L_qaok_38
    s_add_u32 s56, s56, 1
    s_cmp_lt_u32 s56, 0x40000
    s_cbranch_scc0 L_qaok_38
    s_sleep 2
    s_branch L_qa_37
L_qaok_38:
    v_add_f32 v64, v64, v66
    v_add_f32 v68, v68, v70
    v_add_f32 v64, v64, v68
    v_cvt_pk_bf16_f32 v64, v64, v64
    v_add_f32 v72, v72, v74
    v_add_f32 v76, v76, v78
    v_add_f32 v72, v72, v76
    v_cvt_pk_bf16_f32 v72, v72, v72
    v_lshlrev_b32 v60, 1, v0
    ds_write_b16 v60, v64 offset:896
    ds_write_b16 v60, v72 offset:1408
    s_waitcnt lgkmcnt(0)
    s_mov_b64 exec, 1
    ds_add_u32 v13, v14 offset:16
    s_mov_b64 exec, -1
    s_branch L_loop_c
L_refA_11:
    s_lshl_b32 s50, s50, 12
    s_add_u32 s47, s7, s50
    s_mov_b32 s48, 0x1000
    buffer_load_dwordx4 a[0:3], v4, s[8:11], s47 offen offset:0 nt
    buffer_load_dwordx4 a[4:7], v4, s[8:11], s47 offen offset:64 nt
    buffer_load_dwordx4 a[8:11], v4, s[8:11], s47 offen offset:128 nt
    buffer_load_dwordx4 a[12:15], v4, s[8:11], s47 offen offset:192 nt
    s_branch L_afterK_13
L_refI_12:
    s_mov_b32 s48, 0x8000
    s_mov_b32 s47, 0x7ff00000
    s_cmp_lg_u32 s6, 0
    s_cbranch_scc1 L_normK_14
    s_mov_b32 s6, 1
    v_lshlrev_b32 v61, 12, v3
    v_lshl_add_u32 v61, v2, 4, v61
    s_bfe_u32 s50, s62, 0x50002
    s_lshl_b32 s50, s50, 17
    s_lshl_b32 s51, s3, 15
    s_add_u32 s50, s50, s51
    s_and_b32 s51, s62, 3
    s_lshl_b32 s51, s51, 8
    s_add_u32 s50, s50, s51
    s_add_u32 s50, s50, 0
    buffer_load_dwordx4 v[64:67], v61, s[36:39], s50 offen offset:0 nt
    buffer_load_dwordx4 v[68:71], v61, s[36:39], s50 offen offset:1024 nt
    buffer_load_dwordx4 v[72:75], v61, s[36:39], s50 offen offset:2048 nt
    buffer_load_dwordx4 v[76:79], v61, s[36:39], s50 offen offset:3072 nt
    s_branch L_afterK_13
L_vx_15:
    s_cmp_ge_u32 s48, 0x8000
    s_cbranch_scc1 L_vx_15_i
    buffer_load_dwordx4 a[16:19], v5, s[12:15], s47 offen offset:0 nt
    buffer_load_dwordx4 a[20:23], v5, s[12:15], s47 offen offset:256 nt
    buffer_load_dwordx4 a[24:27], v5, s[12:15], s47 offen offset:512 nt
    buffer_load_dwordx4 a[28:31], v5, s[12:15], s47 offen offset:768 nt
    s_branch L_afterV_16
L_vx_15_i:
    s_cmp_lg_u32 s6, 1
    s_cbranch_scc1 L_afterV_16_n
    s_mov_b32 s6, 2
    v_lshlrev_b32 v61, 12, v3
    v_lshl_add_u32 v61, v2, 4, v61
    s_bfe_u32 s50, s62, 0x50002
    s_lshl_b32 s50, s50, 17
    s_lshl_b32 s51, s3, 15
    s_add_u32 s50, s50, s51
    s_and_b32 s51, s62, 3
    s_lshl_b32 s51, s51, 8
    s_add_u32 s50, s50, s51
    s_add_u32 s50, s50, 16384
    buffer_load_dwordx4 v[80:83], v61, s[36:39], s50 offen offset:0 nt
    buffer_load_dwordx4 v[84:87], v61, s[36:39], s50 offen offset:1024 nt
    buffer_load_dwordx4 v[88:91], v61, s[36:39], s50 offen offset:2048 nt
    buffer_load_dwordx4 v[92:95], v61, s[36:39], s50 offen offset:3072 nt
    s_branch L_afterV_16
L_cA_9:
    s_cmp_lg_u32 s63, 0
    s_cbranch_scc1 L_qa_40
    s_mov_b32 s56, 0
L_qsp_41:
    ds_read_b32 v58, v13 offset:16
    s_waitcnt lgkmcnt(0)
    v_readfirstlane_b32 s50, v58
    s_add_u32 s56, s56, 1
    s_cmp_ge_u32 s56, 0x400000
    s_cbranch_scc1 L_qsp_41_x
    s_cmp_lt_u32 s50, 4
    s_cbranch_scc1 L_qsp_41
L_qsp_41_x:
    v_lshrrev_b32 v58, 2, v2
    v_lshlrev_b32 v58, 8, v58
    v_lshl_add_u32 v58, v3, 4, v58
    ds_read_b128 v[208:211], v58 offset:896
    ds_read_b128 v[212:215], v58 offset:960
    ds_read_b128 v[216:219], v58 offset:1024
    ds_read_b128 v[220:223], v58 offset:1088
    s_waitcnt lgkmcnt(0)
    s_mov_b32 s63, 1
L_qa_40:
    s_mov_b64 exec, 1
    ds_add_rtn_u32 v15, v13, v14
    s_mov_b64 exec, -1
    s_waitcnt vmcnt(20)
    v_mfma_f32_16x16x32_bf16 v[16:19], a[0:3], v[208:211], 0
    v_mfma_f32_16x16x32_bf16 v[16:19], a[4:7], v[212:215], v[16:19]
    v_mfma_f32_16x16x32_bf16 v[16:19], a[8:11], v[216:219], v[16:19]
    v_mfma_f32_16x16x32_bf16 v[16:19], a[12:15], v[220:223], v[16:19]
    s_waitcnt lgkmcnt(0)
    v_readfirstlane_b32 s48, v15
    s_nop 3
    s_mov_b32 s91, s48
    s_sub_u32 s50, s48, s5
    s_cmp_lt_u32 s50, 16
    s_cbranch_scc1 L_refA_42
    s_cmp_ge_u32 s48, 272
    s_cbranch_scc1 L_refI_43
    s_cmp_ge_u32 s48, s5
    s_cselect_b32 s50, 16, 0
    s_sub_u32 s50, s48, s50
    s_lshl_b32 s50, s50, 12
    s_add_u32 s47, s46, s50
L_normK_45:
    buffer_load_dwordx4 a[0:3], v4, s[16:19], s47 offen offset:0 nt
    buffer_load_dwordx4 a[4:7], v4, s[16:19], s47 offen offset:64 nt
    buffer_load_dwordx4 a[8:11], v4, s[16:19], s47 offen offset:128 nt
    buffer_load_dwordx4 a[12:15], v4, s[16:19], s47 offen offset:192 nt
L_afterK_44:
    v_cvt_pk_bf16_f32 v58, v16, v17
    v_cvt_pk_bf16_f32 v59, v18, v19
    v_lshlrev_b32 v16, 16, v58
    v_and_b32 v17, 0xffff0000, v58
    v_lshlrev_b32 v18, 16, v59
    v_and_b32 v19, 0xffff0000, v59
    v_mul_f32 v16, s101, v16
    v_mul_f32 v17, s101, v17
    v_mul_f32 v18, s101, v18
    v_mul_f32 v19, s101, v19
    v_cvt_pk_bf16_f32 v58, v16, v17
    v_cvt_pk_bf16_f32 v59, v18, v19
    v_lshlrev_b32 v16, 16, v58
    v_and_b32 v17, 0xffff0000, v58
    v_lshlrev_b32 v18, 16, v59
    v_and_b32 v19, 0xffff0000, v59
    v_max3_f32 v58, v16, v17, v18
    v_max_f32 v58, v58, v19
    v_cmp_gt_f32 vcc, v58, v232
    s_cbranch_vccz L_fast_48
    v_mov_b32 v59, v58
    s_nop 1
    v_permlane32_swap_b32 v59, v58
    s_nop 1
    v_max_f32 v58, v58, v59
    v_mov_b32 v59, v58
    s_nop 1
    v_permlane16_swap_b32 v59, v58
    s_nop 1
    v_max_f32 v58, v58, v59
    v_max_f32 v232, v232, v58
    v_mul_f32 v59, s45, v232
    v_sub_f32 v60, v233, v59
    v_exp_f32 v60, v60
    v_mov_b32 v233, v59
    v_mul_f32 v234, v234, v60
    v_mul_f32 v224, v224, v60
    v_mul_f32 v225, v225, v60
    v_mul_f32 v226, v226, v60
    v_mul_f32 v227, v227, v60
    v_mul_f32 v228, v228, v60
    v_mul_f32 v229, v229, v60
    v_mul_f32 v230, v230, v60
    v_mul_f32 v231, v231, v60
L_fast_48:
    v_fma_f32 v44, v16, s45, -v233
    v_fma_f32 v45, v17, s45, -v233
    v_fma_f32 v46, v18, s45, -v233
    v_fma_f32 v47, v19, s45, -v233
    v_exp_f32 v44, v44
    v_exp_f32 v45, v45
    v_exp_f32 v46, v46
    v_exp_f32 v47, v47
    s_nop 0
    v_cvt_pk_bf16_f32 v48, v44, v45
    v_cvt_pk_bf16_f32 v49, v46, v47
    v_add_f32 v44, v44, v45
    v_add_f32 v46, v46, v47
    v_perm_b32 v50, v48, v48, v6
    v_perm_b32 v51, v48, v48, v7
    v_perm_b32 v52, v48, v48, v8
    v_perm_b32 v53, v48, v48, v9
    v_perm_b32 v54, v49, v49, v6
    v_perm_b32 v55, v49, v49, v7
    v_perm_b32 v56, v49, v49, v8
    v_perm_b32 v57, v49, v49, v9
    v_add_f32 v234, v234, v44
    v_add_f32 v234, v234, v46
    s_waitcnt vmcnt(20)
    v_mfma_f32_16x16x16_bf16 v[224:227], a[16:17], v[50:51], v[224:227]
    v_mfma_f32_16x16x16_bf16 v[228:231], a[18:19], v[50:51], v[228:231]
    v_mfma_f32_16x16x16_bf16 v[224:227], a[20:21], v[52:53], v[224:227]
    v_mfma_f32_16x16x16_bf16 v[228:231], a[22:23], v[52:53], v[228:231]
    v_mfma_f32_16x16x16_bf16 v[224:227], a[24:25], v[54:55], v[224:227]
    v_mfma_f32_16x16x16_bf16 v[228:231], a[26:27], v[54:55], v[228:231]
    v_mfma_f32_16x16x16_bf16 v[224:227], a[28:29], v[56:57], v[224:227]
    v_mfma_f32_16x16x16_bf16 v[228:231], a[30:31], v[56:57], v[228:231]
    s_cmp_ge_u32 s48, 0x1000
    s_cbranch_scc1 L_vx_46
L_afterV_47_n:
    buffer_load_dwordx4 a[16:19], v5, s[20:23], s47 offen offset:0 nt
    buffer_load_dwordx4 a[20:23], v5, s[20:23], s47 offen offset:256 nt
    buffer_load_dwordx4 a[24:27], v5, s[20:23], s47 offen offset:512 nt
    buffer_load_dwordx4 a[28:31], v5, s[20:23], s47 offen offset:768 nt
L_afterV_47:
    s_branch L_cR_10
L_refA_20:
    s_lshl_b32 s50, s50, 12
    s_add_u32 s47, s7, s50
    s_mov_b32 s49, 0x1000
    buffer_load_dwordx4 a[32:35], v4, s[8:11], s47 offen offset:0 nt
    buffer_load_dwordx4 a[36:39], v4, s[8:11], s47 offen offset:64 nt
    buffer_load_dwordx4 a[40:43], v4, s[8:11], s47 offen offset:128 nt
    buffer_load_dwordx4 a[44:47], v4, s[8:11], s47 offen offset:192 nt
    s_branch L_afterK_22
L_refI_21:
    s_mov_b32 s49, 0x8000
    s_mov_b32 s47, 0x7ff00000
    s_cmp_lg_u32 s6, 0
    s_cbranch_scc1 L_normK_23
    s_mov_b32 s6, 1
    v_lshlrev_b32 v61, 12, v3
    v_lshl_add_u32 v61, v2, 4, v61
    s_bfe_u32 s50, s62, 0x50002
    s_lshl_b32 s50, s50, 17
    s_lshl_b32 s51, s3, 15
    s_add_u32 s50, s50, s51
    s_and_b32 s51, s62, 3
    s_lshl_b32 s51, s51, 8
    s_add_u32 s50, s50, s51
    s_add_u32 s50, s50, 0
    buffer_load_dwordx4 v[64:67], v61, s[36:39], s50 offen offset:0 nt
    buffer_load_dwordx4 v[68:71], v61, s[36:39], s50 offen offset:1024 nt
    buffer_load_dwordx4 v[72:75], v61, s[36:39], s50 offen offset:2048 nt
    buffer_load_dwordx4 v[76:79], v61, s[36:39], s50 offen offset:3072 nt
    s_branch L_afterK_22
L_vx_24:
    s_cmp_ge_u32 s49, 0x8000
    s_cbranch_scc1 L_vx_24_i
    buffer_load_dwordx4 a[48:51], v5, s[12:15], s47 offen offset:0 nt
    buffer_load_dwordx4 a[52:55], v5, s[12:15], s47 offen offset:256 nt
    buffer_load_dwordx4 a[56:59], v5, s[12:15], s47 offen offset:512 nt
    buffer_load_dwordx4 a[60:63], v5, s[12:15], s47 offen offset:768 nt
    s_branch L_afterV_25
L_vx_24_i:
    s_cmp_lg_u32 s6, 1
    s_cbranch_scc1 L_afterV_25_n
    s_mov_b32 s6, 2
    v_lshlrev_b32 v61, 12, v3
    v_lshl_add_u32 v61, v2, 4, v61
    s_bfe_u32 s50, s62, 0x50002
    s_lshl_b32 s50, s50, 17
    s_lshl_b32 s51, s3, 15
    s_add_u32 s50, s50, s51
    s_and_b32 s51, s62, 3
    s_lshl_b32 s51, s51, 8
    s_add_u32 s50, s50, s51
    s_add_u32 s50, s50, 16384
    buffer_load_dwordx4 v[80:83], v61, s[36:39], s50 offen offset:0 nt
    buffer_load_dwordx4 v[84:87], v61, s[36:39], s50 offen offset:1024 nt
    buffer_load_dwordx4 v[88:91], v61, s[36:39], s50 offen offset:2048 nt
    buffer_load_dwordx4 v[92:95], v61, s[36:39], s50 offen offset:3072 nt
    s_branch L_afterV_25
L_cA_18:
    s_cmp_lg_u32 s63, 0
    s_cbranch_scc1 L_qa_49
    s_mov_b32 s56, 0
L_qsp_50:
    ds_read_b32 v58, v13 offset:16
    s_waitcnt lgkmcnt(0)
    v_readfirstlane_b32 s50, v58
    s_add_u32 s56, s56, 1
    s_cmp_ge_u32 s56, 0x400000
    s_cbranch_scc1 L_qsp_50_x
    s_cmp_lt_u32 s50, 4
    s_cbranch_scc1 L_qsp_50
L_qsp_50_x:
    v_lshrrev_b32 v58, 2, v2
    v_lshlrev_b32 v58, 8, v58
    v_lshl_add_u32 v58, v3, 4, v58
    ds_read_b128 v[208:211], v58 offset:896
    ds_read_b128 v[212:215], v58 offset:960
    ds_read_b128 v[216:219], v58 offset:1024
    ds_read_b128 v[220:223], v58 offset:1088
    s_waitcnt lgkmcnt(0)
    s_mov_b32 s63, 1
L_qa_49:
    s_mov_b64 exec, 1
    ds_add_rtn_u32 v15, v13, v14
    s_mov_b64 exec, -1
    s_waitcnt vmcnt(20)
    v_mfma_f32_16x16x32_bf16 v[16:19], a[32:35], v[208:211], 0
    v_mfma_f32_16x16x32_bf16 v[16:19], a[36:39], v[212:215], v[16:19]
    v_mfma_f32_16x16x32_bf16 v[16:19], a[40:43], v[216:219], v[16:19]
    v_mfma_f32_16x16x32_bf16 v[16:19], a[44:47], v[220:223], v[16:19]
    s_waitcnt lgkmcnt(0)
    v_readfirstlane_b32 s49, v15
    s_nop 3
    s_mov_b32 s91, s49
    s_sub_u32 s50, s49, s5
    s_cmp_lt_u32 s50, 16
    s_cbranch_scc1 L_refA_51
    s_cmp_ge_u32 s49, 272
    s_cbranch_scc1 L_refI_52
    s_cmp_ge_u32 s49, s5
    s_cselect_b32 s50, 16, 0
    s_sub_u32 s50, s49, s50
    s_lshl_b32 s50, s50, 12
    s_add_u32 s47, s46, s50
L_normK_54:
    buffer_load_dwordx4 a[32:35], v4, s[16:19], s47 offen offset:0 nt
    buffer_load_dwordx4 a[36:39], v4, s[16:19], s47 offen offset:64 nt
    buffer_load_dwordx4 a[40:43], v4, s[16:19], s47 offen offset:128 nt
    buffer_load_dwordx4 a[44:47], v4, s[16:19], s47 offen offset:192 nt
L_afterK_53:
    v_cvt_pk_bf16_f32 v58, v16, v17
    v_cvt_pk_bf16_f32 v59, v18, v19
    v_lshlrev_b32 v16, 16, v58
    v_and_b32 v17, 0xffff0000, v58
    v_lshlrev_b32 v18, 16, v59
    v_and_b32 v19, 0xffff0000, v59
    v_mul_f32 v16, s101, v16
    v_mul_f32 v17, s101, v17
    v_mul_f32 v18, s101, v18
    v_mul_f32 v19, s101, v19
    v_cvt_pk_bf16_f32 v58, v16, v17
    v_cvt_pk_bf16_f32 v59, v18, v19
    v_lshlrev_b32 v16, 16, v58
    v_and_b32 v17, 0xffff0000, v58
    v_lshlrev_b32 v18, 16, v59
    v_and_b32 v19, 0xffff0000, v59
    v_max3_f32 v58, v16, v17, v18
    v_max_f32 v58, v58, v19
    v_cmp_gt_f32 vcc, v58, v232
    s_cbranch_vccz L_fast_57
    v_mov_b32 v59, v58
    s_nop 1
    v_permlane32_swap_b32 v59, v58
    s_nop 1
    v_max_f32 v58, v58, v59
    v_mov_b32 v59, v58
    s_nop 1
    v_permlane16_swap_b32 v59, v58
    s_nop 1
    v_max_f32 v58, v58, v59
    v_max_f32 v232, v232, v58
    v_mul_f32 v59, s45, v232
    v_sub_f32 v60, v233, v59
    v_exp_f32 v60, v60
    v_mov_b32 v233, v59
    v_mul_f32 v234, v234, v60
    v_mul_f32 v224, v224, v60
    v_mul_f32 v225, v225, v60
    v_mul_f32 v226, v226, v60
    v_mul_f32 v227, v227, v60
    v_mul_f32 v228, v228, v60
    v_mul_f32 v229, v229, v60
    v_mul_f32 v230, v230, v60
    v_mul_f32 v231, v231, v60
L_fast_57:
    v_fma_f32 v44, v16, s45, -v233
    v_fma_f32 v45, v17, s45, -v233
    v_fma_f32 v46, v18, s45, -v233
    v_fma_f32 v47, v19, s45, -v233
    v_exp_f32 v44, v44
    v_exp_f32 v45, v45
    v_exp_f32 v46, v46
    v_exp_f32 v47, v47
    s_nop 0
    v_cvt_pk_bf16_f32 v48, v44, v45
    v_cvt_pk_bf16_f32 v49, v46, v47
    v_add_f32 v44, v44, v45
    v_add_f32 v46, v46, v47
    v_perm_b32 v50, v48, v48, v6
    v_perm_b32 v51, v48, v48, v7
    v_perm_b32 v52, v48, v48, v8
    v_perm_b32 v53, v48, v48, v9
    v_perm_b32 v54, v49, v49, v6
    v_perm_b32 v55, v49, v49, v7
    v_perm_b32 v56, v49, v49, v8
    v_perm_b32 v57, v49, v49, v9
    v_add_f32 v234, v234, v44
    v_add_f32 v234, v234, v46
    s_waitcnt vmcnt(20)
    v_mfma_f32_16x16x16_bf16 v[224:227], a[48:49], v[50:51], v[224:227]
    v_mfma_f32_16x16x16_bf16 v[228:231], a[50:51], v[50:51], v[228:231]
    v_mfma_f32_16x16x16_bf16 v[224:227], a[52:53], v[52:53], v[224:227]
    v_mfma_f32_16x16x16_bf16 v[228:231], a[54:55], v[52:53], v[228:231]
    v_mfma_f32_16x16x16_bf16 v[224:227], a[56:57], v[54:55], v[224:227]
    v_mfma_f32_16x16x16_bf16 v[228:231], a[58:59], v[54:55], v[228:231]
    v_mfma_f32_16x16x16_bf16 v[224:227], a[60:61], v[56:57], v[224:227]
    v_mfma_f32_16x16x16_bf16 v[228:231], a[62:63], v[56:57], v[228:231]
    s_cmp_ge_u32 s49, 0x1000
    s_cbranch_scc1 L_vx_55
L_afterV_56_n:
    buffer_load_dwordx4 a[48:51], v5, s[20:23], s47 offen offset:0 nt
    buffer_load_dwordx4 a[52:55], v5, s[20:23], s47 offen offset:256 nt
    buffer_load_dwordx4 a[56:59], v5, s[20:23], s47 offen offset:512 nt
    buffer_load_dwordx4 a[60:63], v5, s[20:23], s47 offen offset:768 nt
L_afterV_56:
    s_branch L_cR_19
L_refA_29:
    s_lshl_b32 s50, s50, 12
    s_add_u32 s47, s7, s50
    s_mov_b32 s4, 0x1000
    buffer_load_dwordx4 a[64:67], v4, s[8:11], s47 offen offset:0 nt
    buffer_load_dwordx4 a[68:71], v4, s[8:11], s47 offen offset:64 nt
    buffer_load_dwordx4 a[72:75], v4, s[8:11], s47 offen offset:128 nt
    buffer_load_dwordx4 a[76:79], v4, s[8:11], s47 offen offset:192 nt
    s_branch L_afterK_31
L_refI_30:
    s_mov_b32 s4, 0x8000
    s_mov_b32 s47, 0x7ff00000
    s_cmp_lg_u32 s6, 0
    s_cbranch_scc1 L_normK_32
    s_mov_b32 s6, 1
    v_lshlrev_b32 v61, 12, v3
    v_lshl_add_u32 v61, v2, 4, v61
    s_bfe_u32 s50, s62, 0x50002
    s_lshl_b32 s50, s50, 17
    s_lshl_b32 s51, s3, 15
    s_add_u32 s50, s50, s51
    s_and_b32 s51, s62, 3
    s_lshl_b32 s51, s51, 8
    s_add_u32 s50, s50, s51
    s_add_u32 s50, s50, 0
    buffer_load_dwordx4 v[64:67], v61, s[36:39], s50 offen offset:0 nt
    buffer_load_dwordx4 v[68:71], v61, s[36:39], s50 offen offset:1024 nt
    buffer_load_dwordx4 v[72:75], v61, s[36:39], s50 offen offset:2048 nt
    buffer_load_dwordx4 v[76:79], v61, s[36:39], s50 offen offset:3072 nt
    s_branch L_afterK_31
L_vx_33:
    s_cmp_ge_u32 s4, 0x8000
    s_cbranch_scc1 L_vx_33_i
    buffer_load_dwordx4 a[80:83], v5, s[12:15], s47 offen offset:0 nt
    buffer_load_dwordx4 a[84:87], v5, s[12:15], s47 offen offset:256 nt
    buffer_load_dwordx4 a[88:91], v5, s[12:15], s47 offen offset:512 nt
    buffer_load_dwordx4 a[92:95], v5, s[12:15], s47 offen offset:768 nt
    s_branch L_afterV_34
L_vx_33_i:
    s_cmp_lg_u32 s6, 1
    s_cbranch_scc1 L_afterV_34_n
    s_mov_b32 s6, 2
    v_lshlrev_b32 v61, 12, v3
    v_lshl_add_u32 v61, v2, 4, v61
    s_bfe_u32 s50, s62, 0x50002
    s_lshl_b32 s50, s50, 17
    s_lshl_b32 s51, s3, 15
    s_add_u32 s50, s50, s51
    s_and_b32 s51, s62, 3
    s_lshl_b32 s51, s51, 8
    s_add_u32 s50, s50, s51
    s_add_u32 s50, s50, 16384
    buffer_load_dwordx4 v[80:83], v61, s[36:39], s50 offen offset:0 nt
    buffer_load_dwordx4 v[84:87], v61, s[36:39], s50 offen offset:1024 nt
    buffer_load_dwordx4 v[88:91], v61, s[36:39], s50 offen offset:2048 nt
    buffer_load_dwordx4 v[92:95], v61, s[36:39], s50 offen offset:3072 nt
    s_branch L_afterV_34
L_cA_27:
    s_cmp_lg_u32 s63, 0
    s_cbranch_scc1 L_qa_58
    s_mov_b32 s56, 0
L_qsp_59:
    ds_read_b32 v58, v13 offset:16
    s_waitcnt lgkmcnt(0)
    v_readfirstlane_b32 s50, v58
    s_add_u32 s56, s56, 1
    s_cmp_ge_u32 s56, 0x400000
    s_cbranch_scc1 L_qsp_59_x
    s_cmp_lt_u32 s50, 4
    s_cbranch_scc1 L_qsp_59
L_qsp_59_x:
    v_lshrrev_b32 v58, 2, v2
    v_lshlrev_b32 v58, 8, v58
    v_lshl_add_u32 v58, v3, 4, v58
    ds_read_b128 v[208:211], v58 offset:896
    ds_read_b128 v[212:215], v58 offset:960
    ds_read_b128 v[216:219], v58 offset:1024
    ds_read_b128 v[220:223], v58 offset:1088
    s_waitcnt lgkmcnt(0)
    s_mov_b32 s63, 1
L_qa_58:
    s_mov_b64 exec, 1
    ds_add_rtn_u32 v15, v13, v14
    s_mov_b64 exec, -1
    s_waitcnt vmcnt(20)
    v_mfma_f32_16x16x32_bf16 v[16:19], a[64:67], v[208:211], 0
    v_mfma_f32_16x16x32_bf16 v[16:19], a[68:71], v[212:215], v[16:19]
    v_mfma_f32_16x16x32_bf16 v[16:19], a[72:75], v[216:219], v[16:19]
    v_mfma_f32_16x16x32_bf16 v[16:19], a[76:79], v[220:223], v[16:19]
    s_waitcnt lgkmcnt(0)
    v_readfirstlane_b32 s4, v15
    s_nop 3
    s_mov_b32 s91, s4
    s_sub_u32 s50, s4, s5
    s_cmp_lt_u32 s50, 16
    s_cbranch_scc1 L_refA_60
    s_cmp_ge_u32 s4, 272
    s_cbranch_scc1 L_refI_61
    s_cmp_ge_u32 s4, s5
    s_cselect_b32 s50, 16, 0
    s_sub_u32 s50, s4, s50
    s_lshl_b32 s50, s50, 12
    s_add_u32 s47, s46, s50
L_normK_63:
    buffer_load_dwordx4 a[64:67], v4, s[16:19], s47 offen offset:0 nt
    buffer_load_dwordx4 a[68:71], v4, s[16:19], s47 offen offset:64 nt
    buffer_load_dwordx4 a[72:75], v4, s[16:19], s47 offen offset:128 nt
    buffer_load_dwordx4 a[76:79], v4, s[16:19], s47 offen offset:192 nt
L_afterK_62:
    v_cvt_pk_bf16_f32 v58, v16, v17
    v_cvt_pk_bf16_f32 v59, v18, v19
    v_lshlrev_b32 v16, 16, v58
    v_and_b32 v17, 0xffff0000, v58
    v_lshlrev_b32 v18, 16, v59
    v_and_b32 v19, 0xffff0000, v59
    v_mul_f32 v16, s101, v16
    v_mul_f32 v17, s101, v17
    v_mul_f32 v18, s101, v18
    v_mul_f32 v19, s101, v19
    v_cvt_pk_bf16_f32 v58, v16, v17
    v_cvt_pk_bf16_f32 v59, v18, v19
    v_lshlrev_b32 v16, 16, v58
    v_and_b32 v17, 0xffff0000, v58
    v_lshlrev_b32 v18, 16, v59
    v_and_b32 v19, 0xffff0000, v59
    v_max3_f32 v58, v16, v17, v18
    v_max_f32 v58, v58, v19
    v_cmp_gt_f32 vcc, v58, v232
    s_cbranch_vccz L_fast_66
    v_mov_b32 v59, v58
    s_nop 1
    v_permlane32_swap_b32 v59, v58
    s_nop 1
    v_max_f32 v58, v58, v59
    v_mov_b32 v59, v58
    s_nop 1
    v_permlane16_swap_b32 v59, v58
    s_nop 1
    v_max_f32 v58, v58, v59
    v_max_f32 v232, v232, v58
    v_mul_f32 v59, s45, v232
    v_sub_f32 v60, v233, v59
    v_exp_f32 v60, v60
    v_mov_b32 v233, v59
    v_mul_f32 v234, v234, v60
    v_mul_f32 v224, v224, v60
    v_mul_f32 v225, v225, v60
    v_mul_f32 v226, v226, v60
    v_mul_f32 v227, v227, v60
    v_mul_f32 v228, v228, v60
    v_mul_f32 v229, v229, v60
    v_mul_f32 v230, v230, v60
    v_mul_f32 v231, v231, v60
L_fast_66:
    v_fma_f32 v44, v16, s45, -v233
    v_fma_f32 v45, v17, s45, -v233
    v_fma_f32 v46, v18, s45, -v233
    v_fma_f32 v47, v19, s45, -v233
    v_exp_f32 v44, v44
    v_exp_f32 v45, v45
    v_exp_f32 v46, v46
    v_exp_f32 v47, v47
    s_nop 0
    v_cvt_pk_bf16_f32 v48, v44, v45
    v_cvt_pk_bf16_f32 v49, v46, v47
    v_add_f32 v44, v44, v45
    v_add_f32 v46, v46, v47
    v_perm_b32 v50, v48, v48, v6
    v_perm_b32 v51, v48, v48, v7
    v_perm_b32 v52, v48, v48, v8
    v_perm_b32 v53, v48, v48, v9
    v_perm_b32 v54, v49, v49, v6
    v_perm_b32 v55, v49, v49, v7
    v_perm_b32 v56, v49, v49, v8
    v_perm_b32 v57, v49, v49, v9
    v_add_f32 v234, v234, v44
    v_add_f32 v234, v234, v46
    s_waitcnt vmcnt(20)
    v_mfma_f32_16x16x16_bf16 v[224:227], a[80:81], v[50:51], v[224:227]
    v_mfma_f32_16x16x16_bf16 v[228:231], a[82:83], v[50:51], v[228:231]
    v_mfma_f32_16x16x16_bf16 v[224:227], a[84:85], v[52:53], v[224:227]
    v_mfma_f32_16x16x16_bf16 v[228:231], a[86:87], v[52:53], v[228:231]
    v_mfma_f32_16x16x16_bf16 v[224:227], a[88:89], v[54:55], v[224:227]
    v_mfma_f32_16x16x16_bf16 v[228:231], a[90:91], v[54:55], v[228:231]
    v_mfma_f32_16x16x16_bf16 v[224:227], a[92:93], v[56:57], v[224:227]
    v_mfma_f32_16x16x16_bf16 v[228:231], a[94:95], v[56:57], v[228:231]
    s_cmp_ge_u32 s4, 0x1000
    s_cbranch_scc1 L_vx_64
L_afterV_65_n:
    buffer_load_dwordx4 a[80:83], v5, s[20:23], s47 offen offset:0 nt
    buffer_load_dwordx4 a[84:87], v5, s[20:23], s47 offen offset:256 nt
    buffer_load_dwordx4 a[88:91], v5, s[20:23], s47 offen offset:512 nt
    buffer_load_dwordx4 a[92:95], v5, s[20:23], s47 offen offset:768 nt
L_afterV_65:
    s_branch L_cR_28
L_refA_42:
    s_lshl_b32 s50, s50, 12
    s_add_u32 s47, s7, s50
    s_mov_b32 s48, 0x1000
    buffer_load_dwordx4 a[0:3], v4, s[8:11], s47 offen offset:0 nt
    buffer_load_dwordx4 a[4:7], v4, s[8:11], s47 offen offset:64 nt
    buffer_load_dwordx4 a[8:11], v4, s[8:11], s47 offen offset:128 nt
    buffer_load_dwordx4 a[12:15], v4, s[8:11], s47 offen offset:192 nt
    s_branch L_afterK_44
L_refI_43:
    s_mov_b32 s48, 0x8000
    s_mov_b32 s47, 0x7ff00000
    s_cmp_lg_u32 s6, 0
    s_cbranch_scc1 L_normK_45
    s_mov_b32 s6, 1
    v_lshlrev_b32 v61, 12, v3
    v_lshl_add_u32 v61, v2, 4, v61
    s_bfe_u32 s50, s62, 0x50002
    s_lshl_b32 s50, s50, 17
    s_lshl_b32 s51, s3, 15
    s_add_u32 s50, s50, s51
    s_and_b32 s51, s62, 3
    s_lshl_b32 s51, s51, 8
    s_add_u32 s50, s50, s51
    s_add_u32 s50, s50, 0
    buffer_load_dwordx4 v[64:67], v61, s[36:39], s50 offen offset:0 nt
    buffer_load_dwordx4 v[68:71], v61, s[36:39], s50 offen offset:1024 nt
    buffer_load_dwordx4 v[72:75], v61, s[36:39], s50 offen offset:2048 nt
    buffer_load_dwordx4 v[76:79], v61, s[36:39], s50 offen offset:3072 nt
    s_branch L_afterK_44
L_vx_46:
    s_cmp_ge_u32 s48, 0x8000
    s_cbranch_scc1 L_vx_46_i
    buffer_load_dwordx4 a[16:19], v5, s[12:15], s47 offen offset:0 nt
    buffer_load_dwordx4 a[20:23], v5, s[12:15], s47 offen offset:256 nt
    buffer_load_dwordx4 a[24:27], v5, s[12:15], s47 offen offset:512 nt
    buffer_load_dwordx4 a[28:31], v5, s[12:15], s47 offen offset:768 nt
    s_branch L_afterV_47
L_vx_46_i:
    s_cmp_lg_u32 s6, 1
    s_cbranch_scc1 L_afterV_47_n
    s_mov_b32 s6, 2
    v_lshlrev_b32 v61, 12, v3
    v_lshl_add_u32 v61, v2, 4, v61
    s_bfe_u32 s50, s62, 0x50002
    s_lshl_b32 s50, s50, 17
    s_lshl_b32 s51, s3, 15
    s_add_u32 s50, s50, s51
    s_and_b32 s51, s62, 3
    s_lshl_b32 s51, s51, 8
    s_add_u32 s50, s50, s51
    s_add_u32 s50, s50, 16384
    buffer_load_dwordx4 v[80:83], v61, s[36:39], s50 offen offset:0 nt
    buffer_load_dwordx4 v[84:87], v61, s[36:39], s50 offen offset:1024 nt
    buffer_load_dwordx4 v[88:91], v61, s[36:39], s50 offen offset:2048 nt
    buffer_load_dwordx4 v[92:95], v61, s[36:39], s50 offen offset:3072 nt
    s_branch L_afterV_47
L_refA_51:
    s_lshl_b32 s50, s50, 12
    s_add_u32 s47, s7, s50
    s_mov_b32 s49, 0x1000
    buffer_load_dwordx4 a[32:35], v4, s[8:11], s47 offen offset:0 nt
    buffer_load_dwordx4 a[36:39], v4, s[8:11], s47 offen offset:64 nt
    buffer_load_dwordx4 a[40:43], v4, s[8:11], s47 offen offset:128 nt
    buffer_load_dwordx4 a[44:47], v4, s[8:11], s47 offen offset:192 nt
    s_branch L_afterK_53
L_refI_52:
    s_mov_b32 s49, 0x8000
    s_mov_b32 s47, 0x7ff00000
    s_cmp_lg_u32 s6, 0
    s_cbranch_scc1 L_normK_54
    s_mov_b32 s6, 1
    v_lshlrev_b32 v61, 12, v3
    v_lshl_add_u32 v61, v2, 4, v61
    s_bfe_u32 s50, s62, 0x50002
    s_lshl_b32 s50, s50, 17
    s_lshl_b32 s51, s3, 15
    s_add_u32 s50, s50, s51
    s_and_b32 s51, s62, 3
    s_lshl_b32 s51, s51, 8
    s_add_u32 s50, s50, s51
    s_add_u32 s50, s50, 0
    buffer_load_dwordx4 v[64:67], v61, s[36:39], s50 offen offset:0 nt
    buffer_load_dwordx4 v[68:71], v61, s[36:39], s50 offen offset:1024 nt
    buffer_load_dwordx4 v[72:75], v61, s[36:39], s50 offen offset:2048 nt
    buffer_load_dwordx4 v[76:79], v61, s[36:39], s50 offen offset:3072 nt
    s_branch L_afterK_53
L_vx_55:
    s_cmp_ge_u32 s49, 0x8000
    s_cbranch_scc1 L_vx_55_i
    buffer_load_dwordx4 a[48:51], v5, s[12:15], s47 offen offset:0 nt
    buffer_load_dwordx4 a[52:55], v5, s[12:15], s47 offen offset:256 nt
    buffer_load_dwordx4 a[56:59], v5, s[12:15], s47 offen offset:512 nt
    buffer_load_dwordx4 a[60:63], v5, s[12:15], s47 offen offset:768 nt
    s_branch L_afterV_56
L_vx_55_i:
    s_cmp_lg_u32 s6, 1
    s_cbranch_scc1 L_afterV_56_n
    s_mov_b32 s6, 2
    v_lshlrev_b32 v61, 12, v3
    v_lshl_add_u32 v61, v2, 4, v61
    s_bfe_u32 s50, s62, 0x50002
    s_lshl_b32 s50, s50, 17
    s_lshl_b32 s51, s3, 15
    s_add_u32 s50, s50, s51
    s_and_b32 s51, s62, 3
    s_lshl_b32 s51, s51, 8
    s_add_u32 s50, s50, s51
    s_add_u32 s50, s50, 16384
    buffer_load_dwordx4 v[80:83], v61, s[36:39], s50 offen offset:0 nt
    buffer_load_dwordx4 v[84:87], v61, s[36:39], s50 offen offset:1024 nt
    buffer_load_dwordx4 v[88:91], v61, s[36:39], s50 offen offset:2048 nt
    buffer_load_dwordx4 v[92:95], v61, s[36:39], s50 offen offset:3072 nt
    s_branch L_afterV_56
L_refA_60:
    s_lshl_b32 s50, s50, 12
    s_add_u32 s47, s7, s50
    s_mov_b32 s4, 0x1000
    buffer_load_dwordx4 a[64:67], v4, s[8:11], s47 offen offset:0 nt
    buffer_load_dwordx4 a[68:71], v4, s[8:11], s47 offen offset:64 nt
    buffer_load_dwordx4 a[72:75], v4, s[8:11], s47 offen offset:128 nt
    buffer_load_dwordx4 a[76:79], v4, s[8:11], s47 offen offset:192 nt
    s_branch L_afterK_62
L_refI_61:
    s_mov_b32 s4, 0x8000
    s_mov_b32 s47, 0x7ff00000
    s_cmp_lg_u32 s6, 0
    s_cbranch_scc1 L_normK_63
    s_mov_b32 s6, 1
    v_lshlrev_b32 v61, 12, v3
    v_lshl_add_u32 v61, v2, 4, v61
    s_bfe_u32 s50, s62, 0x50002
    s_lshl_b32 s50, s50, 17
    s_lshl_b32 s51, s3, 15
    s_add_u32 s50, s50, s51
    s_and_b32 s51, s62, 3
    s_lshl_b32 s51, s51, 8
    s_add_u32 s50, s50, s51
    s_add_u32 s50, s50, 0
    buffer_load_dwordx4 v[64:67], v61, s[36:39], s50 offen offset:0 nt
    buffer_load_dwordx4 v[68:71], v61, s[36:39], s50 offen offset:1024 nt
    buffer_load_dwordx4 v[72:75], v61, s[36:39], s50 offen offset:2048 nt
    buffer_load_dwordx4 v[76:79], v61, s[36:39], s50 offen offset:3072 nt
    s_branch L_afterK_62
L_vx_64:
    s_cmp_ge_u32 s4, 0x8000
    s_cbranch_scc1 L_vx_64_i
    buffer_load_dwordx4 a[80:83], v5, s[12:15], s47 offen offset:0 nt
    buffer_load_dwordx4 a[84:87], v5, s[12:15], s47 offen offset:256 nt
    buffer_load_dwordx4 a[88:91], v5, s[12:15], s47 offen offset:512 nt
    buffer_load_dwordx4 a[92:95], v5, s[12:15], s47 offen offset:768 nt
    s_branch L_afterV_65
L_vx_64_i:
    s_cmp_lg_u32 s6, 1
    s_cbranch_scc1 L_afterV_65_n
    s_mov_b32 s6, 2
    v_lshlrev_b32 v61, 12, v3
    v_lshl_add_u32 v61, v2, 4, v61
    s_bfe_u32 s50, s62, 0x50002
    s_lshl_b32 s50, s50, 17
    s_lshl_b32 s51, s3, 15
    s_add_u32 s50, s50, s51
    s_and_b32 s51, s62, 3
    s_lshl_b32 s51, s51, 8
    s_add_u32 s50, s50, s51
    s_add_u32 s50, s50, 16384
    buffer_load_dwordx4 v[80:83], v61, s[36:39], s50 offen offset:0 nt
    buffer_load_dwordx4 v[84:87], v61, s[36:39], s50 offen offset:1024 nt
    buffer_load_dwordx4 v[88:91], v61, s[36:39], s50 offen offset:2048 nt
    buffer_load_dwordx4 v[92:95], v61, s[36:39], s50 offen offset:3072 nt
    s_branch L_afterV_65
L_done:
    v_mov_b32 v59, v12
    s_nop 1
    v_permlane32_swap_b32 v59, v12
    s_nop 1
    v_add_f32 v12, v12, v59
    v_mov_b32 v59, v12
    s_nop 1
    v_permlane16_swap_b32 v59, v12
    s_nop 1
    v_add_f32 v12, v12, v59
    s_nop 7
    ds_write_b32 v62, v20 offset:18688
    ds_write_b32 v62, v21 offset:18720
    ds_write_b32 v62, v22 offset:18752
    ds_write_b32 v62, v23 offset:18784
    ds_write_b32 v62, v24 offset:18704
    ds_write_b32 v62, v25 offset:18736
    ds_write_b32 v62, v26 offset:18768
    ds_write_b32 v62, v27 offset:18800
    v_lshrrev_b32 v58, 2, v2
    v_lshlrev_b32 v58, 3, v58
    s_lshl_b32 s50, s3, 5
    v_add_u32 v58, s50, v58
    v_mov_b32 v60, v11
    v_mov_b32 v61, v12
    ds_write_b64 v58, v[60:61] offset:256
    s_waitcnt lgkmcnt(0)
    s_mov_b64 exec, 1
    ds_add_rtn_u32 v58, v13, v14 offset:8
    s_mov_b64 exec, -1
    s_waitcnt lgkmcnt(0)
    v_readfirstlane_b32 s50, v58
    s_nop 3
    s_cmp_lg_u32 s50, 3
    s_cbranch_scc1 L_nomerge_67
    v_and_b32 v58, 3, v1
    v_lshlrev_b32 v58, 3, v58
    ds_read_b64 v[96:97], v58 offset:256
    ds_read_b64 v[98:99], v58 offset:288
    ds_read_b64 v[100:101], v58 offset:320
    ds_read_b64 v[102:103], v58 offset:352
    v_lshlrev_b32 v59, 3, v1
    ds_read_b64 v[108:109], v59 offset:18688
    ds_read_b64 v[110:111], v59 offset:20736
    ds_read_b64 v[112:113], v59 offset:22784
    ds_read_b64 v[114:115], v59 offset:24832
    s_waitcnt lgkmcnt(4)
    v_max3_f32 v104, v96, v98, v100
    v_max_f32 v104, v104, v102
    v_sub_f32 v96, v96, v104
    v_sub_f32 v98, v98, v104
    v_sub_f32 v100, v100, v104
    v_sub_f32 v102, v102, v104
    v_exp_f32 v96, v96
    v_exp_f32 v98, v98
    v_exp_f32 v100, v100
    v_exp_f32 v102, v102
    s_nop 0
    v_mul_f32 v106, v96, v97
    v_fmac_f32 v106, v98, v99
    v_fmac_f32 v106, v100, v101
    v_fmac_f32 v106, v102, v103
    v_mov_b32 v105, s44
    v_mov_b32 v107, s44
    v_readlane_b32 s64, v96, 0
    v_readlane_b32 s65, v98, 0
    v_readlane_b32 s66, v100, 0
    v_readlane_b32 s67, v102, 0
    s_waitcnt lgkmcnt(0)
    v_mul_f32 v140, s64, v108
    v_mul_f32 v142, s64, v109
    v_fmac_f32 v140, s65, v110
    v_fmac_f32 v142, s65, v111
    v_fmac_f32 v140, s66, v112
    v_fmac_f32 v142, s66, v113
    v_fmac_f32 v140, s67, v114
    v_fmac_f32 v142, s67, v115
    v_mov_b32 v141, s44
    v_mov_b32 v143, s44
    s_mul_i32 s50, s2, 1088
    s_add_u32 s50, s50, 3145728
    v_lshlrev_b32 v59, 4, v1
    buffer_store_dwordx4 v[140:143], v59, s[24:27], s50 offen offset:0 sc0 sc1
    s_add_u32 s50, s50, 1024
    s_mov_b64 exec, 15
    buffer_store_dwordx4 v[104:107], v59, s[24:27], s50 offen sc0 sc1
    s_mov_b64 exec, -1
L_nomerge_67:
    s_cmp_eq_u32 s90, -1
    s_cbranch_scc1 L_done2
    v_mov_b32 v59, v234
    s_nop 1
    v_permlane32_swap_b32 v59, v234
    s_nop 1
    v_add_f32 v234, v234, v59
    v_mov_b32 v59, v234
    s_nop 1
    v_permlane16_swap_b32 v59, v234
    s_nop 1
    v_add_f32 v234, v234, v59
    s_nop 7
    ds_write_b32 v62, v224 offset:10496
    ds_write_b32 v62, v225 offset:10528
    ds_write_b32 v62, v226 offset:10560
    ds_write_b32 v62, v227 offset:10592
    ds_write_b32 v62, v228 offset:10512
    ds_write_b32 v62, v229 offset:10544
    ds_write_b32 v62, v230 offset:10576
    ds_write_b32 v62, v231 offset:10608
    v_lshrrev_b32 v58, 2, v2
    v_lshlrev_b32 v58, 3, v58
    s_lshl_b32 s50, s3, 5
    v_add_u32 v58, s50, v58
    v_mov_b32 v60, v233
    v_mov_b32 v61, v234
    ds_write_b64 v58, v[60:61] offset:0
    s_waitcnt lgkmcnt(0)
    s_mov_b64 exec, 1
    ds_add_rtn_u32 v58, v13, v14 offset:4
    s_mov_b64 exec, -1
    s_waitcnt lgkmcnt(0)
    v_readfirstlane_b32 s50, v58
    s_nop 3
    s_cmp_lg_u32 s50, 3
    s_cbranch_scc1 L_nomerge_68
    v_and_b32 v58, 3, v1
    v_lshlrev_b32 v58, 3, v58
    ds_read_b64 v[96:97], v58 offset:0
    ds_read_b64 v[98:99], v58 offset:32
    ds_read_b64 v[100:101], v58 offset:64
    ds_read_b64 v[102:103], v58 offset:96
    v_lshlrev_b32 v59, 3, v1
    ds_read_b64 v[108:109], v59 offset:10496
    ds_read_b64 v[110:111], v59 offset:12544
    ds_read_b64 v[112:113], v59 offset:14592
    ds_read_b64 v[114:115], v59 offset:16640
    ds_read_b64 v[116:117], v59 offset:11008
    ds_read_b64 v[118:119], v59 offset:13056
    ds_read_b64 v[120:121], v59 offset:15104
    ds_read_b64 v[122:123], v59 offset:17152
    ds_read_b64 v[124:125], v59 offset:11520
    ds_read_b64 v[126:127], v59 offset:13568
    ds_read_b64 v[128:129], v59 offset:15616
    ds_read_b64 v[130:131], v59 offset:17664
    ds_read_b64 v[132:133], v59 offset:12032
    ds_read_b64 v[134:135], v59 offset:14080
    ds_read_b64 v[136:137], v59 offset:16128
    ds_read_b64 v[138:139], v59 offset:18176
    s_waitcnt lgkmcnt(15)
    s_waitcnt lgkmcnt(12)
    v_max3_f32 v104, v96, v98, v100
    v_max_f32 v104, v104, v102
    v_sub_f32 v96, v96, v104
    v_sub_f32 v98, v98, v104
    v_sub_f32 v100, v100, v104
    v_sub_f32 v102, v102, v104
    v_exp_f32 v96, v96
    v_exp_f32 v98, v98
    v_exp_f32 v100, v100
    v_exp_f32 v102, v102
    s_nop 0
    v_mul_f32 v106, v96, v97
    v_fmac_f32 v106, v98, v99
    v_fmac_f32 v106, v100, v101
    v_fmac_f32 v106, v102, v103
    v_mov_b32 v105, s44
    v_mov_b32 v107, s44
    v_readlane_b32 s64, v96, 0
    v_readlane_b32 s65, v98, 0
    v_readlane_b32 s66, v100, 0
    v_readlane_b32 s67, v102, 0
    v_readlane_b32 s68, v96, 1
    v_readlane_b32 s69, v98, 1
    v_readlane_b32 s70, v100, 1
    v_readlane_b32 s71, v102, 1
    v_readlane_b32 s72, v96, 2
    v_readlane_b32 s73, v98, 2
    v_readlane_b32 s74, v100, 2
    v_readlane_b32 s75, v102, 2
    v_readlane_b32 s76, v96, 3
    v_readlane_b32 s77, v98, 3
    v_readlane_b32 s78, v100, 3
    v_readlane_b32 s79, v102, 3
    s_waitcnt lgkmcnt(0)
    v_mul_f32 v140, s64, v108
    v_mul_f32 v142, s64, v109
    v_fmac_f32 v140, s65, v110
    v_fmac_f32 v142, s65, v111
    v_fmac_f32 v140, s66, v112
    v_fmac_f32 v142, s66, v113
    v_fmac_f32 v140, s67, v114
    v_fmac_f32 v142, s67, v115
    v_mov_b32 v141, s44
    v_mov_b32 v143, s44
    v_mul_f32 v144, s68, v116
    v_mul_f32 v146, s68, v117
    v_fmac_f32 v144, s69, v118
    v_fmac_f32 v146, s69, v119
    v_fmac_f32 v144, s70, v120
    v_fmac_f32 v146, s70, v121
    v_fmac_f32 v144, s71, v122
    v_fmac_f32 v146, s71, v123
    v_mov_b32 v145, s44
    v_mov_b32 v147, s44
    v_mul_f32 v148, s72, v124
    v_mul_f32 v150, s72, v125
    v_fmac_f32 v148, s73, v126
    v_fmac_f32 v150, s73, v127
    v_fmac_f32 v148, s74, v128
    v_fmac_f32 v150, s74, v129
    v_fmac_f32 v148, s75, v130
    v_fmac_f32 v150, s75, v131
    v_mov_b32 v149, s44
    v_mov_b32 v151, s44
    v_mul_f32 v152, s76, v132
    v_mul_f32 v154, s76, v133
    v_fmac_f32 v152, s77, v134
    v_fmac_f32 v154, s77, v135
    v_fmac_f32 v152, s78, v136
    v_fmac_f32 v154, s78, v137
    v_fmac_f32 v152, s79, v138
    v_fmac_f32 v154, s79, v139
    v_mov_b32 v153, s44
    v_mov_b32 v155, s44
    s_mul_i32 s50, s2, 4352
    s_add_u32 s50, s50, 1048576
    v_lshlrev_b32 v59, 4, v1
    buffer_store_dwordx4 v[140:143], v59, s[24:27], s50 offen offset:0 sc0 sc1
    buffer_store_dwordx4 v[144:147], v59, s[24:27], s50 offen offset:1024 sc0 sc1
    buffer_store_dwordx4 v[148:151], v59, s[24:27], s50 offen offset:2048 sc0 sc1
    buffer_store_dwordx4 v[152:155], v59, s[24:27], s50 offen offset:3072 sc0 sc1
    s_add_u32 s50, s50, 4096
    s_mov_b64 exec, 15
    buffer_store_dwordx4 v[104:107], v59, s[24:27], s50 offen sc0 sc1
    s_mov_b64 exec, -1
L_nomerge_68:
L_done2:
    s_cmp_lt_u32 s62, 128
    s_cbranch_scc1 L_tailA
    s_bfe_u32 s50, s62, 0x50002
    s_mul_i32 s58, s50, 4352
    s_add_u32 s58, s58, 3145728
    s_mov_b32 s53, 139264
    v_bfe_u32 v200, v2, 2, 1
    v_mul_lo_u32 v200, v200, s53
    v_and_b32 v58, 3, v2
    s_mov_b32 s53, 1088
    v_mul_lo_u32 v58, v58, s53
    v_add_u32 v200, v200, v58
    v_lshl_add_u32 v201, v3, 5, v200
    s_lshl_b32 s51, s3, 8
    s_add_u32 s92, s58, s51
    s_add_u32 s93, s58, 1024
    s_mov_b32 s56, 0
L_brec_69:
    buffer_load_dwordx4 v[160:163], v201, s[24:27], s92 offen offset:0 sc0 sc1
    buffer_load_dwordx4 v[164:167], v201, s[24:27], s92 offen offset:16 sc0 sc1
    buffer_load_dwordx4 v[168:171], v201, s[24:27], s92 offen offset:128 sc0 sc1
    buffer_load_dwordx4 v[172:175], v201, s[24:27], s92 offen offset:144 sc0 sc1
    buffer_load_dwordx4 v[176:179], v200, s[24:27], s93 offen sc0 sc1
    s_waitcnt vmcnt(0)
L_brecchk_71:
    v_xor_b32 v63, s44, v161
    v_xor_b32 v163, s44, v163
    v_or_b32 v63, v63, v163
    v_xor_b32 v165, s44, v165
    v_or_b32 v63, v63, v165
    v_xor_b32 v167, s44, v167
    v_or_b32 v63, v63, v167
    v_xor_b32 v169, s44, v169
    v_or_b32 v63, v63, v169
    v_xor_b32 v171, s44, v171
    v_or_b32 v63, v63, v171
    v_xor_b32 v173, s44, v173
    v_or_b32 v63, v63, v173
    v_xor_b32 v175, s44, v175
    v_or_b32 v63, v63, v175
    v_xor_b32 v177, s44, v177
    v_or_b32 v63, v63, v177
    v_xor_b32 v179, s44, v179
    v_or_b32 v63, v63, v179
    v_cmp_ne_u32 vcc, 0, v63
    s_cbranch_vccz L_brecok_70
    s_add_u32 s56, s56, 1
    s_cmp_lt_u32 s56, 0x40000
    s_cbranch_scc0 L_brecok_70
    s_sleep 1
    s_branch L_brec_69
L_brecok_70:
    v_mov_b32 v148, v176
    v_mov_b32 v149, v178
    v_mov_b32 v150, v160
    v_mov_b32 v151, v162
    v_mov_b32 v152, v164
    v_mov_b32 v153, v166
    v_mov_b32 v154, v168
    v_mov_b32 v155, v170
    v_mov_b32 v156, v172
    v_mov_b32 v157, v174
    v_mov_b32 v60, v148
    s_nop 1
    v_max_f32_dpp v60, v60, v60 quad_perm:[1,0,3,2] row_mask:0xf bank_mask:0xf
    s_nop 1
    v_max_f32_dpp v60, v60, v60 quad_perm:[2,3,0,1] row_mask:0xf bank_mask:0xf
    v_sub_f32 v148, v148, v60
    v_exp_f32 v148, v148
    s_nop 0
    v_mul_f32 v149, v149, v148
    v_mul_f32 v150, v150, v148
    v_mul_f32 v151, v151, v148
    v_mul_f32 v152, v152, v148
    v_mul_f32 v153, v153, v148
    v_mul_f32 v154, v154, v148
    v_mul_f32 v155, v155, v148
    v_mul_f32 v156, v156, v148
    v_mul_f32 v157, v157, v148
    v_add_f32_dpp v149, v149, v149 quad_perm:[1,0,3,2] row_mask:0xf bank_mask:0xf
    v_add_f32_dpp v150, v150, v150 quad_perm:[1,0,3,2] row_mask:0xf bank_mask:0xf
    v_add_f32_dpp v151, v151, v151 quad_perm:[1,0,3,2] row_mask:0xf bank_mask:0xf
    v_add_f32_dpp v152, v152, v152 quad_perm:[1,0,3,2] row_mask:0xf bank_mask:0xf
    v_add_f32_dpp v153, v153, v153 quad_perm:[1,0,3,2] row_mask:0xf bank_mask:0xf
    v_add_f32_dpp v154, v154, v154 quad_perm:[1,0,3,2] row_mask:0xf bank_mask:0xf
    v_add_f32_dpp v155, v155, v155 quad_perm:[1,0,3,2] row_mask:0xf bank_mask:0xf
    v_add_f32_dpp v156, v156, v156 quad_perm:[1,0,3,2] row_mask:0xf bank_mask:0xf
    v_add_f32_dpp v157, v157, v157 quad_perm:[1,0,3,2] row_mask:0xf bank_mask:0xf
    v_add_f32_dpp v149, v149, v149 quad_perm:[2,3,0,1] row_mask:0xf bank_mask:0xf
    v_add_f32_dpp v150, v150, v150 quad_perm:[2,3,0,1] row_mask:0xf bank_mask:0xf
    v_add_f32_dpp v151, v151, v151 quad_perm:[2,3,0,1] row_mask:0xf bank_mask:0xf
    v_add_f32_dpp v152, v152, v152 quad_perm:[2,3,0,1] row_mask:0xf bank_mask:0xf
    v_add_f32_dpp v153, v153, v153 quad_perm:[2,3,0,1] row_mask:0xf bank_mask:0xf
    v_add_f32_dpp v154, v154, v154 quad_perm:[2,3,0,1] row_mask:0xf bank_mask:0xf
    v_add_f32_dpp v155, v155, v155 quad_perm:[2,3,0,1] row_mask:0xf bank_mask:0xf
    v_add_f32_dpp v156, v156, v156 quad_perm:[2,3,0,1] row_mask:0xf bank_mask:0xf
    v_add_f32_dpp v157, v157, v157 quad_perm:[2,3,0,1] row_mask:0xf bank_mask:0xf
    v_rcp_f32 v149, v149
    s_nop 0
    v_mul_f32 v150, v150, v149
    v_mul_f32 v151, v151, v149
    v_mul_f32 v152, v152, v149
    v_mul_f32 v153, v153, v149
    v_mul_f32 v154, v154, v149
    v_mul_f32 v155, v155, v149
    v_mul_f32 v156, v156, v149
    v_mul_f32 v157, v157, v149
    v_mov_b32 v140, 0
    v_mov_b32 v141, 0
    v_mov_b32 v142, 0
    v_mov_b32 v143, 0
    v_mov_b32 v144, 0
    v_mov_b32 v145, 0
    v_mov_b32 v146, 0
    v_mov_b32 v147, 0
    v_cvt_pk_bf16_f32 v48, v150, v151
    v_cvt_pk_bf16_f32 v49, v152, v153
    v_perm_b32 v50, v48, v48, v6
    v_perm_b32 v51, v48, v48, v7
    v_perm_b32 v52, v48, v48, v8
    v_perm_b32 v53, v48, v48, v9
    v_perm_b32 v54, v49, v49, v6
    v_perm_b32 v55, v49, v49, v7
    v_perm_b32 v56, v49, v49, v8
    v_perm_b32 v57, v49, v49, v9
    s_nop 1
    v_mfma_f32_16x16x16_bf16 v[140:143], v[64:65], v[50:51], v[140:143]
    v_mfma_f32_16x16x16_bf16 v[144:147], v[66:67], v[50:51], v[144:147]
    v_mfma_f32_16x16x16_bf16 v[140:143], v[68:69], v[52:53], v[140:143]
    v_mfma_f32_16x16x16_bf16 v[144:147], v[70:71], v[52:53], v[144:147]
    v_mfma_f32_16x16x16_bf16 v[140:143], v[72:73], v[54:55], v[140:143]
    v_mfma_f32_16x16x16_bf16 v[144:147], v[74:75], v[54:55], v[144:147]
    v_mfma_f32_16x16x16_bf16 v[140:143], v[76:77], v[56:57], v[140:143]
    v_mfma_f32_16x16x16_bf16 v[144:147], v[78:79], v[56:57], v[144:147]
    s_nop 1
    v_cvt_pk_bf16_f32 v48, v154, v155
    v_cvt_pk_bf16_f32 v49, v156, v157
    v_perm_b32 v50, v48, v48, v6
    v_perm_b32 v51, v48, v48, v7
    v_perm_b32 v52, v48, v48, v8
    v_perm_b32 v53, v48, v48, v9
    v_perm_b32 v54, v49, v49, v6
    v_perm_b32 v55, v49, v49, v7
    v_perm_b32 v56, v49, v49, v8
    v_perm_b32 v57, v49, v49, v9
    s_nop 1
    v_mfma_f32_16x16x16_bf16 v[140:143], v[80:81], v[50:51], v[140:143]
    v_mfma_f32_16x16x16_bf16 v[144:147], v[82:83], v[50:51], v[144:147]
    v_mfma_f32_16x16x16_bf16 v[140:143], v[84:85], v[52:53], v[140:143]
    v_mfma_f32_16x16x16_bf16 v[144:147], v[86:87], v[52:53], v[144:147]
    v_mfma_f32_16x16x16_bf16 v[140:143], v[88:89], v[54:55], v[140:143]
    v_mfma_f32_16x16x16_bf16 v[144:147], v[90:91], v[54:55], v[144:147]
    v_mfma_f32_16x16x16_bf16 v[140:143], v[92:93], v[56:57], v[140:143]
    v_mfma_f32_16x16x16_bf16 v[144:147], v[94:95], v[56:57], v[144:147]
    s_nop 1
    s_nop 7
    s_nop 1
    ds_write_b32 v62, v140 offset:2304
    ds_write_b32 v62, v141 offset:2336
    ds_write_b32 v62, v142 offset:2368
    ds_write_b32 v62, v143 offset:2400
    ds_write_b32 v62, v144 offset:2320
    ds_write_b32 v62, v145 offset:2352
    ds_write_b32 v62, v146 offset:2384
    ds_write_b32 v62, v147 offset:2416
    s_waitcnt lgkmcnt(0)
    s_mov_b64 exec, 1
    ds_add_rtn_u32 v58, v13, v14 offset:12
    s_mov_b64 exec, -1
    s_waitcnt lgkmcnt(0)
    v_readfirstlane_b32 s50, v58
    s_nop 3
    s_cmp_lg_u32 s50, 3
    s_cbranch_scc1 L_end
    v_lshlrev_b32 v58, 3, v1
    ds_read_b64 v[96:97], v58 offset:2304
    ds_read_b64 v[98:99], v58 offset:4352
    ds_read_b64 v[100:101], v58 offset:6400
    ds_read_b64 v[102:103], v58 offset:8448
    ds_read_b64 v[104:105], v58 offset:2816
    ds_read_b64 v[106:107], v58 offset:4864
    ds_read_b64 v[108:109], v58 offset:6912
    ds_read_b64 v[110:111], v58 offset:8960
    s_waitcnt lgkmcnt(0)
    v_add_f32 v96, v96, v98
    v_add_f32 v97, v97, v99
    v_add_f32 v100, v100, v102
    v_add_f32 v101, v101, v103
    v_add_f32 v116, v96, v100
    v_add_f32 v118, v97, v101
    v_mov_b32 v117, s44
    v_mov_b32 v119, s44
    v_add_f32 v104, v104, v106
    v_add_f32 v105, v105, v107
    v_add_f32 v108, v108, v110
    v_add_f32 v109, v109, v111
    v_add_f32 v120, v104, v108
    v_add_f32 v122, v105, v109
    v_mov_b32 v121, s44
    v_mov_b32 v123, s44
    v_lshlrev_b32 v58, 4, v1
    s_lshr_b32 s50, s62, 7
    s_lshl_b32 s50, s50, 2
    s_and_b32 s51, s62, 3
    s_add_u32 s50, s50, s51
    s_lshl_b32 s50, s50, 16
    s_bfe_u32 s51, s62, 0x50002
    s_lshl_b32 s51, s51, 11
    s_add_u32 s50, s50, s51
    s_add_u32 s50, s50, 4194304
    buffer_store_dwordx4 v[116:119], v58, s[24:27], s50 offen sc0 sc1
    buffer_store_dwordx4 v[120:123], v58, s[24:27], s50 offen offset:1024 sc0 sc1
    v_lshrrev_b32 v58, 1, v1
    v_lshlrev_b32 v58, 11, v58
    v_and_b32 v59, 1, v1
    v_lshl_add_u32 v58, v59, 10, v58
    s_lshr_b32 s50, s62, 7
    s_lshl_b32 s50, s50, 2
    s_and_b32 s51, s62, 3
    s_add_u32 s50, s50, s51
    s_lshl_b32 s50, s50, 16
    s_bfe_u32 s51, s62, 0x50002
    s_lshl_b32 s51, s51, 5
    s_add_u32 s50, s50, s51
    s_add_u32 s50, s50, 4194304
    s_mov_b32 s56, 0
L_yp_72:
    buffer_load_dwordx4 v[96:99], v58, s[24:27], s50 offen sc0 sc1
    buffer_load_dwordx4 v[100:103], v58, s[24:27], s50 offen offset:16 sc0 sc1
    s_waitcnt vmcnt(0)
L_ypchk_74:
    v_xor_b32 v63, s44, v97
    v_xor_b32 v99, s44, v99
    v_or_b32 v63, v63, v99
    v_xor_b32 v101, s44, v101
    v_or_b32 v63, v63, v101
    v_xor_b32 v103, s44, v103
    v_or_b32 v63, v63, v103
    v_cmp_ne_u32 vcc, 0, v63
    s_cbranch_vccz L_ypok_73
    s_add_u32 s56, s56, 1
    s_cmp_lt_u32 s56, 0x40000
    s_cbranch_scc0 L_ypok_73
    s_sleep 1
    s_branch L_yp_72
L_ypok_73:
    v_add_f32_dpp v96, v96, v96 row_ror:2 row_mask:0xf bank_mask:0xf
    v_add_f32_dpp v98, v98, v98 row_ror:2 row_mask:0xf bank_mask:0xf
    v_add_f32_dpp v100, v100, v100 row_ror:2 row_mask:0xf bank_mask:0xf
    v_add_f32_dpp v102, v102, v102 row_ror:2 row_mask:0xf bank_mask:0xf
    v_add_f32_dpp v96, v96, v96 row_ror:4 row_mask:0xf bank_mask:0xf
    v_add_f32_dpp v98, v98, v98 row_ror:4 row_mask:0xf bank_mask:0xf
    v_add_f32_dpp v100, v100, v100 row_ror:4 row_mask:0xf bank_mask:0xf
    v_add_f32_dpp v102, v102, v102 row_ror:4 row_mask:0xf bank_mask:0xf
    v_add_f32_dpp v96, v96, v96 row_ror:8 row_mask:0xf bank_mask:0xf
    v_add_f32_dpp v98, v98, v98 row_ror:8 row_mask:0xf bank_mask:0xf
    v_add_f32_dpp v100, v100, v100 row_ror:8 row_mask:0xf bank_mask:0xf
    v_add_f32_dpp v102, v102, v102 row_ror:8 row_mask:0xf bank_mask:0xf
    v_mov_b32 v97, v96
    v_mov_b32 v99, v98
    v_mov_b32 v101, v100
    v_mov_b32 v103, v102
    s_nop 1
    v_permlane16_swap_b32 v97, v96
    v_permlane16_swap_b32 v99, v98
    v_permlane16_swap_b32 v101, v100
    v_permlane16_swap_b32 v103, v102
    s_nop 1
    v_add_f32 v96, v96, v97
    v_add_f32 v98, v98, v99
    v_add_f32 v100, v100, v101
    v_add_f32 v102, v102, v103
    v_mov_b32 v97, v96
    v_mov_b32 v99, v98
    v_mov_b32 v101, v100
    v_mov_b32 v103, v102
    s_nop 1
    v_permlane32_swap_b32 v97, v96
    v_permlane32_swap_b32 v99, v98
    v_permlane32_swap_b32 v101, v100
    v_permlane32_swap_b32 v103, v102
    s_nop 1
    v_add_f32 v96, v96, v97
    v_add_f32 v98, v98, v99
    v_add_f32 v100, v100, v101
    v_add_f32 v102, v102, v103
    v_cvt_pk_bf16_f32 v104, v96, v98
    v_cvt_pk_bf16_f32 v105, v100, v102
    v_lshlrev_b32 v59, 11, v59
    s_lshr_b32 s50, s62, 7
    s_lshl_b32 s50, s50, 10
    s_and_b32 s51, s62, 3
    s_lshl_b32 s51, s51, 8
    s_add_u32 s50, s50, s51
    s_bfe_u32 s51, s62, 0x50002
    s_lshl_b32 s51, s51, 3
    s_add_u32 s50, s50, s51
    s_mov_b64 exec, 3
    buffer_store_dwordx2 v[104:105], v59, s[40:43], s50 offen
    s_mov_b64 exec, -1
    s_branch L_end
L_tailA:
    s_bfe_u32 s50, s62, 0x50002
    s_lshr_b32 s51, s50, 2
    s_mul_i32 s58, s51, 69632
    s_add_u32 s58, s58, 1048576
    s_and_b32 s52, s50, 3
    s_mov_b32 s53, 557056
    v_bfe_u32 v200, v2, 2, 1
    v_mul_lo_u32 v200, v200, s53
    v_and_b32 v58, 3, v2
    v_lshrrev_b32 v59, 3, v2
    v_lshl_add_u32 v58, v59, 2, v58
    v_lshlrev_b32 v58, 1, v58
    s_mov_b32 s53, 4352
    v_mul_lo_u32 v58, v58, s53
    v_add_u32 v200, v200, v58
    v_lshl_add_u32 v201, v3, 5, v200
    s_lshl_b32 s51, s3, 8
    s_lshl_b32 s53, s52, 10
    s_add_u32 s92, s58, s51
    s_add_u32 s92, s92, s53
    s_lshl_b32 s53, s52, 4
    s_add_u32 s93, s58, s53
    s_add_u32 s93, s93, 4096
    s_add_u32 s94, s92, 4352
    s_add_u32 s95, s93, 4352
    s_mov_b32 s56, 0
L_arec_75:
    buffer_load_dwordx4 v[160:163], v201, s[24:27], s92 offen offset:0 sc0 sc1
    buffer_load_dwordx4 v[164:167], v201, s[24:27], s92 offen offset:16 sc0 sc1
    buffer_load_dwordx4 v[168:171], v201, s[24:27], s92 offen offset:128 sc0 sc1
    buffer_load_dwordx4 v[172:175], v201, s[24:27], s92 offen offset:144 sc0 sc1
    buffer_load_dwordx4 v[176:179], v200, s[24:27], s93 offen sc0 sc1
    buffer_load_dwordx4 v[180:183], v201, s[24:27], s94 offen offset:0 sc0 sc1
    buffer_load_dwordx4 v[184:187], v201, s[24:27], s94 offen offset:16 sc0 sc1
    buffer_load_dwordx4 v[188:191], v201, s[24:27], s94 offen offset:128 sc0 sc1
    buffer_load_dwordx4 v[192:195], v201, s[24:27], s94 offen offset:144 sc0 sc1
    buffer_load_dwordx4 v[196:199], v200, s[24:27], s95 offen sc0 sc1
    s_waitcnt vmcnt(0)
L_arecchk_77:
    v_xor_b32 v63, s44, v161
    v_xor_b32 v163, s44, v163
    v_or_b32 v63, v63, v163
    v_xor_b32 v165, s44, v165
    v_or_b32 v63, v63, v165
    v_xor_b32 v167, s44, v167
    v_or_b32 v63, v63, v167
    v_xor_b32 v169, s44, v169
    v_or_b32 v63, v63, v169
    v_xor_b32 v171, s44, v171
    v_or_b32 v63, v63, v171
    v_xor_b32 v173, s44, v173
    v_or_b32 v63, v63, v173
    v_xor_b32 v175, s44, v175
    v_or_b32 v63, v63, v175
    v_xor_b32 v177, s44, v177
    v_or_b32 v63, v63, v177
    v_xor_b32 v179, s44, v179
    v_or_b32 v63, v63, v179
    v_xor_b32 v181, s44, v181
    v_or_b32 v63, v63, v181
    v_xor_b32 v183, s44, v183
    v_or_b32 v63, v63, v183
    v_xor_b32 v185, s44, v185
    v_or_b32 v63, v63, v185
    v_xor_b32 v187, s44, v187
    v_or_b32 v63, v63, v187
    v_xor_b32 v189, s44, v189
    v_or_b32 v63, v63, v189
    v_xor_b32 v191, s44, v191
    v_or_b32 v63, v63, v191
    v_xor_b32 v193, s44, v193
    v_or_b32 v63, v63, v193
    v_xor_b32 v195, s44, v195
    v_or_b32 v63, v63, v195
    v_xor_b32 v197, s44, v197
    v_or_b32 v63, v63, v197
    v_xor_b32 v199, s44, v199
    v_or_b32 v63, v63, v199
    v_cmp_ne_u32 vcc, 0, v63
    s_cbranch_vccz L_arecok_76
    s_add_u32 s56, s56, 1
    s_cmp_lt_u32 s56, 0x40000
    s_cbranch_scc0 L_arecok_76
    s_sleep 1
    s_branch L_arec_75
L_arecok_76:
    v_max_f32 v148, v176, v196
    v_sub_f32 v176, v176, v148
    v_sub_f32 v196, v196, v148
    v_exp_f32 v176, v176
    v_exp_f32 v196, v196
    s_nop 0
    v_mul_f32 v149, v176, v178
    v_fmac_f32 v149, v196, v198
    v_mul_f32 v150, v176, v160
    v_fmac_f32 v150, v196, v180
    v_mul_f32 v151, v176, v162
    v_fmac_f32 v151, v196, v182
    v_mul_f32 v152, v176, v164
    v_fmac_f32 v152, v196, v184
    v_mul_f32 v153, v176, v166
    v_fmac_f32 v153, v196, v186
    v_mul_f32 v154, v176, v168
    v_fmac_f32 v154, v196, v188
    v_mul_f32 v155, v176, v170
    v_fmac_f32 v155, v196, v190
    v_mul_f32 v156, v176, v172
    v_fmac_f32 v156, v196, v192
    v_mul_f32 v157, v176, v174
    v_fmac_f32 v157, v196, v194
    v_mov_b32 v60, v148
    s_nop 1
    v_max_f32_dpp v60, v60, v60 quad_perm:[1,0,3,2] row_mask:0xf bank_mask:0xf
    s_nop 1
    v_max_f32_dpp v60, v60, v60 quad_perm:[2,3,0,1] row_mask:0xf bank_mask:0xf
    s_nop 1
    v_max_f32_dpp v60, v60, v60 row_ror:8 row_mask:0xf bank_mask:0xf
    v_sub_f32 v148, v148, v60
    v_exp_f32 v148, v148
    s_nop 0
    v_mul_f32 v149, v149, v148
    v_mul_f32 v150, v150, v148
    v_mul_f32 v151, v151, v148
    v_mul_f32 v152, v152, v148
    v_mul_f32 v153, v153, v148
    v_mul_f32 v154, v154, v148
    v_mul_f32 v155, v155, v148
    v_mul_f32 v156, v156, v148
    v_mul_f32 v157, v157, v148
    v_add_f32_dpp v149, v149, v149 quad_perm:[1,0,3,2] row_mask:0xf bank_mask:0xf
    v_add_f32_dpp v150, v150, v150 quad_perm:[1,0,3,2] row_mask:0xf bank_mask:0xf
    v_add_f32_dpp v151, v151, v151 quad_perm:[1,0,3,2] row_mask:0xf bank_mask:0xf
    v_add_f32_dpp v152, v152, v152 quad_perm:[1,0,3,2] row_mask:0xf bank_mask:0xf
    v_add_f32_dpp v153, v153, v153 quad_perm:[1,0,3,2] row_mask:0xf bank_mask:0xf
    v_add_f32_dpp v154, v154, v154 quad_perm:[1,0,3,2] row_mask:0xf bank_mask:0xf
    v_add_f32_dpp v155, v155, v155 quad_perm:[1,0,3,2] row_mask:0xf bank_mask:0xf
    v_add_f32_dpp v156, v156, v156 quad_perm:[1,0,3,2] row_mask:0xf bank_mask:0xf
    v_add_f32_dpp v157, v157, v157 quad_perm:[1,0,3,2] row_mask:0xf bank_mask:0xf
    v_add_f32_dpp v149, v149, v149 quad_perm:[2,3,0,1] row_mask:0xf bank_mask:0xf
    v_add_f32_dpp v150, v150, v150 quad_perm:[2,3,0,1] row_mask:0xf bank_mask:0xf
    v_add_f32_dpp v151, v151, v151 quad_perm:[2,3,0,1] row_mask:0xf bank_mask:0xf
    v_add_f32_dpp v152, v152, v152 quad_perm:[2,3,0,1] row_mask:0xf bank_mask:0xf
    v_add_f32_dpp v153, v153, v153 quad_perm:[2,3,0,1] row_mask:0xf bank_mask:0xf
    v_add_f32_dpp v154, v154, v154 quad_perm:[2,3,0,1] row_mask:0xf bank_mask:0xf
    v_add_f32_dpp v155, v155, v155 quad_perm:[2,3,0,1] row_mask:0xf bank_mask:0xf
    v_add_f32_dpp v156, v156, v156 quad_perm:[2,3,0,1] row_mask:0xf bank_mask:0xf
    v_add_f32_dpp v157, v157, v157 quad_perm:[2,3,0,1] row_mask:0xf bank_mask:0xf
    v_add_f32_dpp v149, v149, v149 row_ror:8 row_mask:0xf bank_mask:0xf
    v_add_f32_dpp v150, v150, v150 row_ror:8 row_mask:0xf bank_mask:0xf
    v_add_f32_dpp v151, v151, v151 row_ror:8 row_mask:0xf bank_mask:0xf
    v_add_f32_dpp v152, v152, v152 row_ror:8 row_mask:0xf bank_mask:0xf
    v_add_f32_dpp v153, v153, v153 row_ror:8 row_mask:0xf bank_mask:0xf
    v_add_f32_dpp v154, v154, v154 row_ror:8 row_mask:0xf bank_mask:0xf
    v_add_f32_dpp v155, v155, v155 row_ror:8 row_mask:0xf bank_mask:0xf
    v_add_f32_dpp v156, v156, v156 row_ror:8 row_mask:0xf bank_mask:0xf
    v_add_f32_dpp v157, v157, v157 row_ror:8 row_mask:0xf bank_mask:0xf
    v_rcp_f32 v149, v149
    s_nop 0
    v_mul_f32 v150, v150, v149
    v_mul_f32 v151, v151, v149
    v_mul_f32 v152, v152, v149
    v_mul_f32 v153, v153, v149
    v_mul_f32 v154, v154, v149
    v_mul_f32 v155, v155, v149
    v_mul_f32 v156, v156, v149
    v_mul_f32 v157, v157, v149
    v_mov_b32 v140, 0
    v_mov_b32 v141, 0
    v_mov_b32 v142, 0
    v_mov_b32 v143, 0
    v_mov_b32 v144, 0
    v_mov_b32 v145, 0
    v_mov_b32 v146, 0
    v_mov_b32 v147, 0
    v_cvt_pk_bf16_f32 v48, v150, v151
    v_cvt_pk_bf16_f32 v49, v152, v153
    v_perm_b32 v50, v48, v48, v6
    v_perm_b32 v51, v48, v48, v7
    v_perm_b32 v52, v48, v48, v8
    v_perm_b32 v53, v48, v48, v9
    v_perm_b32 v54, v49, v49, v6
    v_perm_b32 v55, v49, v49, v7
    v_perm_b32 v56, v49, v49, v8
    v_perm_b32 v57, v49, v49, v9
    s_nop 1
    v_mfma_f32_16x16x16_bf16 v[140:143], v[64:65], v[50:51], v[140:143]
    v_mfma_f32_16x16x16_bf16 v[144:147], v[66:67], v[50:51], v[144:147]
    v_mfma_f32_16x16x16_bf16 v[140:143], v[68:69], v[52:53], v[140:143]
    v_mfma_f32_16x16x16_bf16 v[144:147], v[70:71], v[52:53], v[144:147]
    v_mfma_f32_16x16x16_bf16 v[140:143], v[72:73], v[54:55], v[140:143]
    v_mfma_f32_16x16x16_bf16 v[144:147], v[74:75], v[54:55], v[144:147]
    v_mfma_f32_16x16x16_bf16 v[140:143], v[76:77], v[56:57], v[140:143]
    v_mfma_f32_16x16x16_bf16 v[144:147], v[78:79], v[56:57], v[144:147]
    s_nop 1
    v_cvt_pk_bf16_f32 v48, v154, v155
    v_cvt_pk_bf16_f32 v49, v156, v157
    v_perm_b32 v50, v48, v48, v6
    v_perm_b32 v51, v48, v48, v7
    v_perm_b32 v52, v48, v48, v8
    v_perm_b32 v53, v48, v48, v9
    v_perm_b32 v54, v49, v49, v6
    v_perm_b32 v55, v49, v49, v7
    v_perm_b32 v56, v49, v49, v8
    v_perm_b32 v57, v49, v49, v9
    s_nop 1
    v_mfma_f32_16x16x16_bf16 v[140:143], v[80:81], v[50:51], v[140:143]
    v_mfma_f32_16x16x16_bf16 v[144:147], v[82:83], v[50:51], v[144:147]
    v_mfma_f32_16x16x16_bf16 v[140:143], v[84:85], v[52:53], v[140:143]
    v_mfma_f32_16x16x16_bf16 v[144:147], v[86:87], v[52:53], v[144:147]
    v_mfma_f32_16x16x16_bf16 v[140:143], v[88:89], v[54:55], v[140:143]
    v_mfma_f32_16x16x16_bf16 v[144:147], v[90:91], v[54:55], v[144:147]
    v_mfma_f32_16x16x16_bf16 v[140:143], v[92:93], v[56:57], v[140:143]
    v_mfma_f32_16x16x16_bf16 v[144:147], v[94:95], v[56:57], v[144:147]
    s_nop 1
    s_nop 7
    s_nop 1
    ds_write_b32 v62, v140 offset:2304
    ds_write_b32 v62, v141 offset:2336
    ds_write_b32 v62, v142 offset:2368
    ds_write_b32 v62, v143 offset:2400
    ds_write_b32 v62, v144 offset:2320
    ds_write_b32 v62, v145 offset:2352
    ds_write_b32 v62, v146 offset:2384
    ds_write_b32 v62, v147 offset:2416
    s_waitcnt lgkmcnt(0)
    s_mov_b64 exec, 1
    ds_add_rtn_u32 v58, v13, v14 offset:12
    s_mov_b64 exec, -1
    s_waitcnt lgkmcnt(0)
    v_readfirstlane_b32 s50, v58
    s_nop 3
    s_cmp_lg_u32 s50, 3
    s_cbranch_scc1 L_end
    v_lshlrev_b32 v58, 3, v1
    ds_read_b64 v[96:97], v58 offset:2304
    ds_read_b64 v[98:99], v58 offset:4352
    ds_read_b64 v[100:101], v58 offset:6400
    ds_read_b64 v[102:103], v58 offset:8448
    ds_read_b64 v[104:105], v58 offset:2816
    ds_read_b64 v[106:107], v58 offset:4864
    ds_read_b64 v[108:109], v58 offset:6912
    ds_read_b64 v[110:111], v58 offset:8960
    s_waitcnt lgkmcnt(0)
    v_add_f32 v96, v96, v98
    v_add_f32 v97, v97, v99
    v_add_f32 v100, v100, v102
    v_add_f32 v101, v101, v103
    v_add_f32 v116, v96, v100
    v_add_f32 v118, v97, v101
    v_mov_b32 v117, s44
    v_mov_b32 v119, s44
    v_add_f32 v104, v104, v106
    v_add_f32 v105, v105, v107
    v_add_f32 v108, v108, v110
    v_add_f32 v109, v109, v111
    v_add_f32 v120, v104, v108
    v_add_f32 v122, v105, v109
    v_mov_b32 v121, s44
    v_mov_b32 v123, s44
    v_lshlrev_b32 v58, 4, v1
    s_lshr_b32 s50, s62, 7
    s_lshl_b32 s50, s50, 2
    s_and_b32 s51, s62, 3
    s_add_u32 s50, s50, s51
    s_lshl_b32 s50, s50, 16
    s_bfe_u32 s51, s62, 0x50002
    s_lshl_b32 s51, s51, 11
    s_add_u32 s50, s50, s51
    s_add_u32 s50, s50, 4194304
    buffer_store_dwordx4 v[116:119], v58, s[24:27], s50 offen sc0 sc1
    buffer_store_dwordx4 v[120:123], v58, s[24:27], s50 offen offset:1024 sc0 sc1
    v_lshrrev_b32 v58, 1, v1
    v_lshlrev_b32 v58, 11, v58
    v_and_b32 v59, 1, v1
    v_lshl_add_u32 v58, v59, 10, v58
    s_lshr_b32 s50, s62, 7
    s_lshl_b32 s50, s50, 2
    s_and_b32 s51, s62, 3
    s_add_u32 s50, s50, s51
    s_lshl_b32 s50, s50, 16
    s_bfe_u32 s51, s62, 0x50002
    s_lshl_b32 s51, s51, 5
    s_add_u32 s50, s50, s51
    s_add_u32 s50, s50, 4194304
    s_mov_b32 s56, 0
L_yp_78:
    buffer_load_dwordx4 v[96:99], v58, s[24:27], s50 offen sc0 sc1
    buffer_load_dwordx4 v[100:103], v58, s[24:27], s50 offen offset:16 sc0 sc1
    s_waitcnt vmcnt(0)
L_ypchk_80:
    v_xor_b32 v63, s44, v97
    v_xor_b32 v99, s44, v99
    v_or_b32 v63, v63, v99
    v_xor_b32 v101, s44, v101
    v_or_b32 v63, v63, v101
    v_xor_b32 v103, s44, v103
    v_or_b32 v63, v63, v103
    v_cmp_ne_u32 vcc, 0, v63
    s_cbranch_vccz L_ypok_79
    s_add_u32 s56, s56, 1
    s_cmp_lt_u32 s56, 0x40000
    s_cbranch_scc0 L_ypok_79
    s_sleep 1
    s_branch L_yp_78
L_ypok_79:
    v_add_f32_dpp v96, v96, v96 row_ror:2 row_mask:0xf bank_mask:0xf
    v_add_f32_dpp v98, v98, v98 row_ror:2 row_mask:0xf bank_mask:0xf
    v_add_f32_dpp v100, v100, v100 row_ror:2 row_mask:0xf bank_mask:0xf
    v_add_f32_dpp v102, v102, v102 row_ror:2 row_mask:0xf bank_mask:0xf
    v_add_f32_dpp v96, v96, v96 row_ror:4 row_mask:0xf bank_mask:0xf
    v_add_f32_dpp v98, v98, v98 row_ror:4 row_mask:0xf bank_mask:0xf
    v_add_f32_dpp v100, v100, v100 row_ror:4 row_mask:0xf bank_mask:0xf
    v_add_f32_dpp v102, v102, v102 row_ror:4 row_mask:0xf bank_mask:0xf
    v_add_f32_dpp v96, v96, v96 row_ror:8 row_mask:0xf bank_mask:0xf
    v_add_f32_dpp v98, v98, v98 row_ror:8 row_mask:0xf bank_mask:0xf
    v_add_f32_dpp v100, v100, v100 row_ror:8 row_mask:0xf bank_mask:0xf
    v_add_f32_dpp v102, v102, v102 row_ror:8 row_mask:0xf bank_mask:0xf
    v_mov_b32 v97, v96
    v_mov_b32 v99, v98
    v_mov_b32 v101, v100
    v_mov_b32 v103, v102
    s_nop 1
    v_permlane16_swap_b32 v97, v96
    v_permlane16_swap_b32 v99, v98
    v_permlane16_swap_b32 v101, v100
    v_permlane16_swap_b32 v103, v102
    s_nop 1
    v_add_f32 v96, v96, v97
    v_add_f32 v98, v98, v99
    v_add_f32 v100, v100, v101
    v_add_f32 v102, v102, v103
    v_mov_b32 v97, v96
    v_mov_b32 v99, v98
    v_mov_b32 v101, v100
    v_mov_b32 v103, v102
    s_nop 1
    v_permlane32_swap_b32 v97, v96
    v_permlane32_swap_b32 v99, v98
    v_permlane32_swap_b32 v101, v100
    v_permlane32_swap_b32 v103, v102
    s_nop 1
    v_add_f32 v96, v96, v97
    v_add_f32 v98, v98, v99
    v_add_f32 v100, v100, v101
    v_add_f32 v102, v102, v103
    v_cvt_pk_bf16_f32 v104, v96, v98
    v_cvt_pk_bf16_f32 v105, v100, v102
    v_lshlrev_b32 v59, 11, v59
    s_lshr_b32 s50, s62, 7
    s_lshl_b32 s50, s50, 10
    s_and_b32 s51, s62, 3
    s_lshl_b32 s51, s51, 8
    s_add_u32 s50, s50, s51
    s_bfe_u32 s51, s62, 0x50002
    s_lshl_b32 s51, s51, 3
    s_add_u32 s50, s50, s51
    s_mov_b64 exec, 3
    buffer_store_dwordx2 v[104:105], v59, s[40:43], s50 offen
    s_mov_b64 exec, -1
    s_cmp_lg_u32 s62, 0
    s_cbranch_scc1 L_end
    s_mov_b64 exec, 1
    v_mov_b32 v74, s44
    buffer_store_dword v74, off, s[24:27], 0 sc0 sc1
L_end:
    s_endpgm
.section .rodata,"a"
.p2align 6
.amdhsa_kernel concat_heads__sliding_block_cached__mha_block_cached__decode_kernel
  .amdhsa_next_free_vgpr 336
  .amdhsa_next_free_sgpr 102
  .amdhsa_accum_offset 240
  .amdhsa_group_segment_fixed_size 0
  .amdhsa_kernarg_size 104
  .amdhsa_user_sgpr_count 2
  .amdhsa_user_sgpr_kernarg_segment_ptr 1
  .amdhsa_system_sgpr_workgroup_id_x 1
.end_amdhsa_kernel
```
